```python
import torch

def _softmax(x, axis=-1):
    return torch.softmax(x, dim=axis)
def _gelu(x):
    return torch.nn.functional.gelu(x, approximate="tanh")
def _silu(x):
    return torch.nn.functional.silu(x)
def _sigmoid(x):
    return torch.sigmoid(x)
def _layernorm(x, axis=-1, eps=1e-5):
    m = x.mean(dim=axis, keepdim=True)
    v = x.var(dim=axis, keepdim=True, unbiased=False)
    return (x - m) / torch.sqrt(v + eps)
def _scatter_add(tgt, idx, src, axis=0):
    return tgt.clone().index_add_(axis, idx, src)
def _segment_sum(src, seg, n):
    out = torch.zeros((n,) + src.shape[1:], dtype=src.dtype)
    return out.index_add_(0, seg, src)
def _pad(x, pw):
    flat = tuple(v for pair in reversed(pw) for v in pair)
    return torch.nn.functional.pad(x, flat)

kernel_name = 'standalone__gqa_softmax__near_ridge'

def setup_inputs():

    _w = (lambda a: (lambda t: t.to(torch.bfloat16) if t.is_floating_point() else t)(torch.as_tensor(a)))
    B, Hq, Hkv, Sq, Sk, D = 16, 32, 32, 384, 512, 128
    return {
        "q": _w((lambda *s: torch.randn(*s, dtype=torch.bfloat16) * 0.8)(B, Hq, Sq, D)),
        "k": _w((lambda *s: torch.randn(*s, dtype=torch.bfloat16) * 0.8)(B, Hkv, Sk, D)),
        "v": _w((lambda *s: torch.randn(*s, dtype=torch.bfloat16) * 0.05)(B, Hkv, Sk, D)),
    }

def reference(q, k, v):
    B, Hq, Sq, D = q.shape
    Hkv = k.shape[1]
    rep = Hq // Hkv
    k = (lambda x, n, axis: torch.repeat_interleave(x, n, dim=axis))(k, rep, axis=1)
    v = (lambda x, n, axis: torch.repeat_interleave(x, n, dim=axis))(v, rep, axis=1)
    scale = D ** -0.5
    scores = torch.einsum("bhqd,bhkd->bhqk", q, k) * scale
    p = _softmax(scores, axis=-1)
    return torch.einsum("bhqk,bhkd->bhqd", p, v)
```

```asm
; @launch grid=(256,1,1) block=(256,1,1) lds=163840
.amdgcn_target "amdgcn-amd-amdhsa--gfx950"
.text
.globl standalone__gqa_softmax__near_ridge_kernel
.p2align 8
.type standalone__gqa_softmax__near_ridge_kernel,@function
standalone__gqa_softmax__near_ridge_kernel:
    s_cmp_ge_u32 s2, 0x100
    s_cbranch_scc1 L_end
    s_load_dwordx8 s[24:31], s[0:1], 0
    v_lshrrev_b32 v1, 6, v0
    v_and_b32 v2, 63, v0
    v_readfirstlane_b32 s3, v1
    s_getpc_b64 s[44:45]
L_pc:
    s_sub_u32 s44, s44, L_pc-standalone__gqa_softmax__near_ridge_kernel
    s_subb_u32 s45, s45, 0
    s_lshr_b32 s43, s2, 3
    s_and_b32 s43, s43, 7
    s_lshl_b32 s43, s43, 12
    v_lshl_add_u32 v6, v0, 4, s43
    v_min_u32 v6, (L_codeend-standalone__gqa_softmax__near_ridge_kernel-16)&0xfff0, v6
    v_mov_b32 v7, s45
    v_add_co_u32 v6, vcc, s44, v6
    s_nop 1
    v_addc_co_u32 v7, vcc, 0, v7, vcc
    global_load_dwordx4 v[228:231], v[6:7], off
    v_bfe_u32 v3, v2, 2, 2
    v_lshrrev_b32 v4, 4, v2
    v_and_b32 v5, 3, v2
    v_lshlrev_b32 v6, 8, v3
    v_lshl_add_u32 v6, v4, 6, v6
    v_lshl_add_u32 v7, v1, 11, v6
    v_and_b32 v8, 2, v1
    v_xor_b32 v8, v8, v5
    v_lshl_add_u32 v249, v8, 4, v7
    s_getreg_b32 s55, hwreg(HW_REG_XCC_ID, 0, 3)
    s_lshl_b32 s55, s55, 2
    s_lshr_b32 s55, 0x6050707, s55
    s_and_b32 s55, s55, 15
    s_lshl_b32 s4, s2, 18
    s_lshl_b32 s6, s3, 11
    s_waitcnt lgkmcnt(0)
    s_add_u32 s8, s26, s4
    s_addc_u32 s9, s27, 0
    s_mov_b32 s10, 0x40000
    s_mov_b32 s11, 0x20000
    s_add_u32 m0, s6, 0x0
    s_mov_b32 s34, 0x0
    buffer_load_dwordx4 v249, s[8:11], s34 offen nt lds
    buffer_load_dwordx4 v249, s[8:11], s34 offen offset:1024 nt lds
    s_add_u32 m0, s6, 0x2000
    s_mov_b32 s34, 0x2000
    buffer_load_dwordx4 v249, s[8:11], s34 offen nt lds
    buffer_load_dwordx4 v249, s[8:11], s34 offen offset:1024 nt lds
    v_mul_u32_u24 v9, 0x6000, v1
    v_add_u32 v6, v6, v9
    v_lshl_add_u32 v251, v5, 4, v6
    s_mul_i32 s5, s2, 0x30000
    s_mul_i32 s7, s3, 0x6000
    s_add_u32 s7, s7, 0x10000
    s_mov_b32 s36, s7
    s_mov_b32 s37, 0
    s_add_u32 s16, s24, s5
    s_addc_u32 s17, s25, 0
    s_mov_b32 s18, 0x30000
    s_mov_b32 s19, 0x20000
    s_mov_b32 m0, s36
    s_nop 0
    buffer_load_dwordx4 v251, s[16:19], s37 offen nt lds
    buffer_load_dwordx4 v251, s[16:19], s37 offen offset:1024 nt lds
    s_add_u32 s36, s36, 0x800
    s_add_u32 s37, s37, 0x800
    v_xor_b32 v251, 32, v251
    s_mov_b32 m0, s36
    s_nop 0
    buffer_load_dwordx4 v251, s[16:19], s37 offen nt lds
    buffer_load_dwordx4 v251, s[16:19], s37 offen offset:1024 nt lds
    s_add_u32 s36, s36, 0x800
    s_add_u32 s37, s37, 0x800
    v_xor_b32 v251, 32, v251
    v_lshlrev_b32 v8, 1, v1
    v_and_b32 v8, 2, v8
    v_xor_b32 v8, v8, v5
    v_lshl_add_u32 v250, v8, 4, v7
    s_add_u32 s12, s28, s4
    s_addc_u32 s13, s29, 0
    s_mov_b32 s14, 0x40000
    s_mov_b32 s15, 0x20000
    s_cmp_lt_u32 s55, 1
    s_cbranch_scc1 L_bw1
    s_waitcnt vmcnt(2)
L_bw1:
    s_add_u32 m0, s6, 0x8000
    s_mov_b32 s34, 0x0
    buffer_load_dwordx4 v250, s[12:15], s34 offen nt lds
    buffer_load_dwordx4 v250, s[12:15], s34 offen offset:1024 nt lds
    s_add_u32 m0, s6, 0xa000
    s_mov_b32 s34, 0x2000
    buffer_load_dwordx4 v250, s[12:15], s34 offen nt lds
    buffer_load_dwordx4 v250, s[12:15], s34 offen offset:1024 nt lds
    s_add_u32 s20, s30, s5
    s_addc_u32 s21, s31, 0
    s_mov_b32 s22, 0x30000
    s_mov_b32 s23, 0x20000
    v_lshlrev_b32 v6, 6, v5
    v_and_b32 v7, 2, v3
    v_xor_b32 v7, v7, v4
    v_lshl_add_u32 v6, v7, 4, v6
    v_lshl_add_u32 v222, v3, 11, v6
    v_lshl_add_u32 v6, v3, 10, v6
    v_add_u32 v248, s7, v6
    v_lshlrev_b32 v6, 11, v4
    v_lshl_add_u32 v6, v3, 6, v6
    v_and_b32 v7, 1, v4
    v_lshl_add_u32 v6, v7, 5, v6
    v_lshrrev_b32 v7, 1, v5
    v_lshl_add_u32 v6, v7, 4, v6
    v_and_b32 v7, 1, v5
    v_lshl_add_u32 v6, v7, 3, v6
    v_xor_b32 v223, 0x8000, v6
    v_xor_b32 v224, 0x8020, v6
    v_lshlrev_b32 v6, 10, v3
    v_lshl_add_u32 v6, v5, 6, v6
    v_bfe_u32 v7, v2, 1, 2
    v_lshlrev_b32 v7, 4, v7
    v_lshlrev_b32 v8, 3, v4
    v_xor_b32 v7, v7, v8
    v_add3_u32 v225, v6, v7, s7
    v_xor_b32 v226, 32, v225
    v_lshl_add_u32 v227, v2, 4, s7
    v_lshl_add_u32 v6, v3, 8, v9
    v_lshl_add_u32 v6, v4, 6, v6
    v_bfe_u32 v7, v2, 3, 1
    v_xor_b32 v7, v7, v5
    v_lshl_add_u32 v244, v7, 4, v6
    v_xor_b32 v245, 32, v244
    v_cmp_eq_u32 vcc, 0, v5
    v_mov_b32 v7, 0x3f803f80
    s_mov_b32 s32, 0x3e0293ee
    v_cndmask_b32 v7, 0, v7, vcc
    v_accvgpr_write_b32 a248, v7
    v_accvgpr_write_b32 a249, v7
    v_accvgpr_write_b32 a250, v7
    v_accvgpr_write_b32 a251, v7
    s_mov_b32 s33, 0xbe0293ee
    s_mov_b32 s38, 6
    s_mov_b32 s40, 0
    s_mov_b32 s54, 0x800
    s_mov_b32 s49, 0x40000
    s_mov_b64 s[50:51], 0
    s_mov_b64 s[52:53], 0
    s_cmp_lt_u32 s55, 2
    s_cbranch_scc1 L_bw2
    s_waitcnt vmcnt(2)
L_bw2:
    s_mov_b32 m0, s36
    s_nop 0
    buffer_load_dwordx4 v251, s[16:19], s37 offen nt lds
    buffer_load_dwordx4 v251, s[16:19], s37 offen offset:1024 nt lds
    s_add_u32 s36, s36, 0x800
    s_add_u32 s37, s37, 0x800
    v_xor_b32 v251, 32, v251
    s_waitcnt vmcnt(10)
    s_barrier
    ds_read_b128 a[96:99], v222 offset:0
    ds_read_b128 a[100:103], v222 offset:256
    ds_read_b128 a[104:107], v222 offset:512
    ds_read_b128 a[108:111], v222 offset:768
    ds_read_b128 a[112:115], v222 offset:1024
    ds_read_b128 a[116:119], v222 offset:1280
    ds_read_b128 a[120:123], v222 offset:1536
    ds_read_b128 a[124:127], v222 offset:1792
    ds_read_b128 a[128:131], v222 offset:8192
    ds_read_b128 a[132:135], v222 offset:8448
    ds_read_b128 a[136:139], v222 offset:8704
    ds_read_b128 a[140:143], v222 offset:8960
    ds_read_b128 a[144:147], v222 offset:9216
    ds_read_b128 a[148:151], v222 offset:9472
    ds_read_b128 a[152:155], v222 offset:9728
    ds_read_b128 a[156:159], v222 offset:9984
    v_xor_b32 v222, 0x4000, v222
    s_cmp_lt_u32 s55, 3
    s_cbranch_scc1 L_bw3
    s_waitcnt vmcnt(2)
L_bw3:
    s_mov_b32 m0, s36
    s_nop 0
    buffer_load_dwordx4 v251, s[16:19], s37 offen nt lds
    buffer_load_dwordx4 v251, s[16:19], s37 offen offset:1024 nt lds
    s_add_u32 s36, s36, 0x800
    s_add_u32 s37, s37, 0x800
    v_xor_b32 v251, 32, v251
    s_mov_b32 m0, s36
    s_nop 0
    buffer_load_dwordx4 v251, s[16:19], s37 offen nt lds
    buffer_load_dwordx4 v251, s[16:19], s37 offen offset:1024 nt lds
    s_add_u32 s36, s36, 0x800
    s_add_u32 s37, s37, 0x800
    v_xor_b32 v251, 32, v251
    s_waitcnt vmcnt(10)
    ds_read_b128 a[0:3], v248 offset:0
    ds_read_b128 a[4:7], v248 offset:256
    ds_read_b128 a[8:11], v248 offset:512
    ds_read_b128 a[12:15], v248 offset:768
    s_waitcnt lgkmcnt(0)
    v_mfma_f32_16x16x32_bf16 v[208:211], a[96:99], a[0:3], 0
    v_mfma_f32_16x16x32_bf16 v[208:211], a[100:103], a[4:7], v[208:211]
    v_mfma_f32_16x16x32_bf16 v[208:211], a[104:107], a[8:11], v[208:211]
    v_mfma_f32_16x16x32_bf16 v[208:211], a[108:111], a[12:15], v[208:211]
    v_mfma_f32_16x16x32_bf16 v[212:215], a[112:115], a[0:3], 0
    v_mfma_f32_16x16x32_bf16 v[212:215], a[116:119], a[4:7], v[212:215]
    v_mfma_f32_16x16x32_bf16 v[212:215], a[120:123], a[8:11], v[212:215]
    v_mfma_f32_16x16x32_bf16 v[212:215], a[124:127], a[12:15], v[212:215]
    s_nop 0
    v_mfma_f32_16x16x32_bf16 v[192:195], a[128:131], a[0:3], 0
    s_nop 0
    v_mfma_f32_16x16x32_bf16 v[192:195], a[132:135], a[4:7], v[192:195]
    s_nop 0
    v_mfma_f32_16x16x32_bf16 v[192:195], a[136:139], a[8:11], v[192:195]
    s_nop 0
    v_max3_f32 v216, v208, v209, v210
    v_max3_f32 v216, v216, v211, v212
    v_mfma_f32_16x16x32_bf16 v[192:195], a[140:143], a[12:15], v[192:195]
    v_max3_f32 v216, v216, v213, v214
    v_max_f32 v216, v216, v215
    v_mfma_f32_16x16x32_bf16 v[196:199], a[144:147], a[0:3], 0
    v_mov_b32 v252, v216
    v_mfma_f32_16x16x32_bf16 v[196:199], a[148:151], a[4:7], v[196:199]
    s_nop 0
    v_permlane16_swap_b32 v252, v216
    v_max_f32 v216, v216, v252
    v_mov_b32 v252, v216
    v_mfma_f32_16x16x32_bf16 v[196:199], a[152:155], a[8:11], v[196:199]
    s_nop 0
    v_permlane32_swap_b32 v252, v216
    v_max_f32 v216, v216, v252
    v_mul_f32 v216, s33, v216
    v_mfma_f32_16x16x32_bf16 v[196:199], a[156:159], a[12:15], v[196:199]
    v_fma_f32 v208, v208, s32, v216
    v_exp_f32 v208, v208
    v_fma_f32 v209, v209, s32, v216
    v_fma_f32 v210, v210, s32, v216
    v_exp_f32 v209, v209
    v_exp_f32 v210, v210
    v_fma_f32 v211, v211, s32, v216
    v_exp_f32 v211, v211
    v_cvt_pk_bf16_f32 v208, v208, v209
    v_cvt_pk_bf16_f32 v209, v210, v211
    v_fma_f32 v212, v212, s32, v216
    v_exp_f32 v212, v212
    v_fma_f32 v213, v213, s32, v216
    v_fma_f32 v192, v192, s32, v216
    v_exp_f32 v213, v213
    v_exp_f32 v192, v192
    v_fma_f32 v214, v214, s32, v216
    v_fma_f32 v193, v193, s32, v216
    v_exp_f32 v214, v214
    v_exp_f32 v193, v193
    v_cvt_pk_bf16_f32 v210, v212, v213
    v_fma_f32 v215, v215, s32, v216
    v_exp_f32 v215, v215
    v_cvt_pk_bf16_f32 v192, v192, v193
    v_fma_f32 v194, v194, s32, v216
    v_exp_f32 v194, v194
    v_fma_f32 v195, v195, s32, v216
    v_fma_f32 v196, v196, s32, v216
    v_exp_f32 v195, v195
    v_exp_f32 v196, v196
    v_fma_f32 v197, v197, s32, v216
    v_exp_f32 v197, v197
    v_fma_f32 v198, v198, s32, v216
    v_exp_f32 v198, v198
    v_fma_f32 v199, v199, s32, v216
    v_exp_f32 v199, v199
    s_cmp_lt_u32 s55, 4
    s_cbranch_scc1 L_bw4
    s_waitcnt vmcnt(2)
L_bw4:
    s_mov_b32 m0, s36
    s_nop 0
    buffer_load_dwordx4 v251, s[16:19], s37 offen nt lds
    buffer_load_dwordx4 v251, s[16:19], s37 offen offset:1024 nt lds
    s_add_u32 s36, s36, 0x800
    s_add_u32 s37, s37, 0x800
    v_xor_b32 v251, 32, v251
    s_mov_b32 m0, s36
    s_nop 0
    buffer_load_dwordx4 v251, s[16:19], s37 offen nt lds
    buffer_load_dwordx4 v251, s[16:19], s37 offen offset:1024 nt lds
    s_add_u32 s36, s36, 0x800
    s_add_u32 s37, s37, 0x800
    v_xor_b32 v251, 32, v251
    s_waitcnt vmcnt(10)
    s_barrier
    ds_read_b64_tr_b16 a[160:161], v223 offset:0
    ds_read_b64_tr_b16 a[162:163], v223 offset:1024
    ds_read_b64_tr_b16 a[164:165], v224 offset:0
    ds_read_b64_tr_b16 a[166:167], v224 offset:1024
    ds_read_b64_tr_b16 a[168:169], v223 offset:256
    ds_read_b64_tr_b16 a[170:171], v223 offset:1280
    ds_read_b64_tr_b16 a[172:173], v224 offset:256
    ds_read_b64_tr_b16 a[174:175], v224 offset:1280
    ds_read_b64_tr_b16 a[176:177], v223 offset:512
    ds_read_b64_tr_b16 a[178:179], v223 offset:1536
    ds_read_b64_tr_b16 a[180:181], v224 offset:512
    ds_read_b64_tr_b16 a[182:183], v224 offset:1536
    ds_read_b64_tr_b16 a[184:185], v223 offset:768
    ds_read_b64_tr_b16 a[186:187], v223 offset:1792
    ds_read_b64_tr_b16 a[188:189], v224 offset:768
    ds_read_b64_tr_b16 a[190:191], v224 offset:1792
    ds_read_b64_tr_b16 a[192:193], v223 offset:8192
    ds_read_b64_tr_b16 a[194:195], v223 offset:9216
    ds_read_b64_tr_b16 a[196:197], v224 offset:8192
    ds_read_b64_tr_b16 a[198:199], v224 offset:9216
    ds_read_b64_tr_b16 a[200:201], v223 offset:8448
    ds_read_b64_tr_b16 a[202:203], v223 offset:9472
    ds_read_b64_tr_b16 a[204:205], v224 offset:8448
    ds_read_b64_tr_b16 a[206:207], v224 offset:9472
    ds_read_b64_tr_b16 a[208:209], v223 offset:8704
    ds_read_b64_tr_b16 a[210:211], v223 offset:9728
    ds_read_b64_tr_b16 a[212:213], v224 offset:8704
    ds_read_b64_tr_b16 a[214:215], v224 offset:9728
    ds_read_b64_tr_b16 a[216:217], v223 offset:8960
    ds_read_b64_tr_b16 a[218:219], v223 offset:9984
    ds_read_b64_tr_b16 a[220:221], v224 offset:8960
    ds_read_b64_tr_b16 a[222:223], v224 offset:9984
    v_xor_b32 v223, 0x4000, v223
    v_xor_b32 v224, 0x4000, v224
    v_cvt_pk_bf16_f32 v211, v214, v215
    v_cvt_pk_bf16_f32 v193, v194, v195
    v_cvt_pk_bf16_f32 v194, v196, v197
    v_cvt_pk_bf16_f32 v195, v198, v199
    s_waitcnt lgkmcnt(0)
    v_mfma_f32_16x16x32_bf16 v[0:3], a[160:163], v[208:211], 0
    v_mfma_f32_16x16x32_bf16 v[0:3], a[192:195], v[192:195], v[0:3]
    v_mfma_f32_16x16x32_bf16 v[4:7], a[164:167], v[208:211], 0
    v_mfma_f32_16x16x32_bf16 v[4:7], a[196:199], v[192:195], v[4:7]
    v_mfma_f32_16x16x32_bf16 v[8:11], a[168:171], v[208:211], 0
    v_mfma_f32_16x16x32_bf16 v[8:11], a[200:203], v[192:195], v[8:11]
    v_mfma_f32_16x16x32_bf16 v[12:15], a[172:175], v[208:211], 0
    v_mfma_f32_16x16x32_bf16 v[12:15], a[204:207], v[192:195], v[12:15]
    v_mfma_f32_16x16x32_bf16 v[16:19], a[176:179], v[208:211], 0
    v_mfma_f32_16x16x32_bf16 v[16:19], a[208:211], v[192:195], v[16:19]
    v_mfma_f32_16x16x32_bf16 v[20:23], a[180:183], v[208:211], 0
    v_mfma_f32_16x16x32_bf16 v[20:23], a[212:215], v[192:195], v[20:23]
    v_mfma_f32_16x16x32_bf16 v[24:27], a[184:187], v[208:211], 0
    v_mfma_f32_16x16x32_bf16 v[24:27], a[216:219], v[192:195], v[24:27]
    v_mfma_f32_16x16x32_bf16 v[28:31], a[188:191], v[208:211], 0
    v_mfma_f32_16x16x32_bf16 v[28:31], a[220:223], v[192:195], v[28:31]
    v_mfma_f32_16x16x32_bf16 a[224:227], a[248:251], v[208:211], 0
    v_mfma_f32_16x16x32_bf16 a[224:227], a[248:251], v[192:195], a[224:227]
    s_barrier
    s_cmp_lt_u32 s55, 5
    s_cbranch_scc1 L_bw5
    s_waitcnt vmcnt(2)
L_bw5:
    s_mov_b32 m0, s36
    s_nop 0
    buffer_load_dwordx4 v251, s[16:19], s37 offen nt lds
    buffer_load_dwordx4 v251, s[16:19], s37 offen offset:1024 nt lds
    s_add_u32 s36, s36, 0x800
    s_add_u32 s37, s37, 0x800
    v_xor_b32 v251, 32, v251
    s_mov_b32 m0, s36
    s_nop 0
    buffer_load_dwordx4 v251, s[16:19], s37 offen nt lds
    buffer_load_dwordx4 v251, s[16:19], s37 offen offset:1024 nt lds
    s_add_u32 s36, s36, 0x800
    s_add_u32 s37, s37, 0x800
    v_xor_b32 v251, 32, v251
    s_waitcnt vmcnt(10)
    ds_read_b128 a[16:19], v248 offset:4096
    ds_read_b128 a[20:23], v248 offset:4352
    ds_read_b128 a[24:27], v248 offset:4608
    ds_read_b128 a[28:31], v248 offset:4864
    s_waitcnt lgkmcnt(0)
    v_mfma_f32_16x16x32_bf16 v[208:211], a[96:99], a[16:19], 0
    v_mfma_f32_16x16x32_bf16 v[208:211], a[100:103], a[20:23], v[208:211]
    v_mfma_f32_16x16x32_bf16 v[208:211], a[104:107], a[24:27], v[208:211]
    v_mfma_f32_16x16x32_bf16 v[208:211], a[108:111], a[28:31], v[208:211]
    v_mfma_f32_16x16x32_bf16 v[212:215], a[112:115], a[16:19], 0
    v_mfma_f32_16x16x32_bf16 v[212:215], a[116:119], a[20:23], v[212:215]
    v_mfma_f32_16x16x32_bf16 v[212:215], a[120:123], a[24:27], v[212:215]
    v_mfma_f32_16x16x32_bf16 v[212:215], a[124:127], a[28:31], v[212:215]
    s_nop 0
    v_mfma_f32_16x16x32_bf16 v[200:203], a[128:131], a[16:19], 0
    s_nop 0
    v_mfma_f32_16x16x32_bf16 v[200:203], a[132:135], a[20:23], v[200:203]
    s_nop 0
    v_mfma_f32_16x16x32_bf16 v[200:203], a[136:139], a[24:27], v[200:203]
    s_nop 0
    v_max3_f32 v217, v208, v209, v210
    v_max3_f32 v217, v217, v211, v212
    v_mfma_f32_16x16x32_bf16 v[200:203], a[140:143], a[28:31], v[200:203]
    v_max3_f32 v217, v217, v213, v214
    v_max_f32 v217, v217, v215
    v_mfma_f32_16x16x32_bf16 v[204:207], a[144:147], a[16:19], 0
    v_mov_b32 v252, v217
    v_mfma_f32_16x16x32_bf16 v[204:207], a[148:151], a[20:23], v[204:207]
    s_nop 0
    v_permlane16_swap_b32 v252, v217
    v_max_f32 v217, v217, v252
    v_mov_b32 v252, v217
    v_mfma_f32_16x16x32_bf16 v[204:207], a[152:155], a[24:27], v[204:207]
    s_nop 0
    v_permlane32_swap_b32 v252, v217
    v_max_f32 v217, v217, v252
    v_mul_f32 v217, s33, v217
    v_mfma_f32_16x16x32_bf16 v[204:207], a[156:159], a[28:31], v[204:207]
    v_fma_f32 v208, v208, s32, v217
    v_exp_f32 v208, v208
    v_fma_f32 v209, v209, s32, v217
    v_fma_f32 v210, v210, s32, v217
    v_exp_f32 v209, v209
    v_exp_f32 v210, v210
    v_fma_f32 v211, v211, s32, v217
    v_exp_f32 v211, v211
    v_cvt_pk_bf16_f32 v208, v208, v209
    v_cvt_pk_bf16_f32 v209, v210, v211
    v_fma_f32 v212, v212, s32, v217
    v_exp_f32 v212, v212
    v_fma_f32 v213, v213, s32, v217
    v_fma_f32 v200, v200, s32, v217
    v_exp_f32 v213, v213
    v_exp_f32 v200, v200
    v_fma_f32 v214, v214, s32, v217
    v_fma_f32 v201, v201, s32, v217
    v_fma_f32 v215, v215, s32, v217
    v_cvt_pk_bf16_f32 v210, v212, v213
    v_exp_f32 v214, v214
    v_exp_f32 v201, v201
    v_exp_f32 v215, v215
    v_fma_f32 v202, v202, s32, v217
    v_cvt_pk_bf16_f32 v200, v200, v201
    v_exp_f32 v202, v202
    v_fma_f32 v203, v203, s32, v217
    v_exp_f32 v203, v203
    v_fma_f32 v204, v204, s32, v217
    v_fma_f32 v205, v205, s32, v217
    v_exp_f32 v204, v204
    v_exp_f32 v205, v205
    v_fma_f32 v206, v206, s32, v217
    v_exp_f32 v206, v206
    v_fma_f32 v207, v207, s32, v217
    v_exp_f32 v207, v207
    v_cvt_pk_bf16_f32 v211, v214, v215
    v_cvt_pk_bf16_f32 v201, v202, v203
    v_cvt_pk_bf16_f32 v202, v204, v205
    v_cvt_pk_bf16_f32 v203, v206, v207
    v_mfma_f32_16x16x32_bf16 v[32:35], a[160:163], v[208:211], 0
    s_nop 0
    v_mfma_f32_16x16x32_bf16 v[32:35], a[192:195], v[200:203], v[32:35]
    v_mfma_f32_16x16x32_bf16 v[36:39], a[164:167], v[208:211], 0
    v_mfma_f32_16x16x32_bf16 v[36:39], a[196:199], v[200:203], v[36:39]
    v_mfma_f32_16x16x32_bf16 v[40:43], a[168:171], v[208:211], 0
    v_mfma_f32_16x16x32_bf16 v[40:43], a[200:203], v[200:203], v[40:43]
    v_mfma_f32_16x16x32_bf16 v[44:47], a[172:175], v[208:211], 0
    v_mfma_f32_16x16x32_bf16 v[44:47], a[204:207], v[200:203], v[44:47]
    v_mfma_f32_16x16x32_bf16 v[48:51], a[176:179], v[208:211], 0
    v_mfma_f32_16x16x32_bf16 v[48:51], a[208:211], v[200:203], v[48:51]
    v_mfma_f32_16x16x32_bf16 v[52:55], a[180:183], v[208:211], 0
    v_mfma_f32_16x16x32_bf16 v[52:55], a[212:215], v[200:203], v[52:55]
    v_mfma_f32_16x16x32_bf16 v[56:59], a[184:187], v[208:211], 0
    v_mfma_f32_16x16x32_bf16 v[56:59], a[216:219], v[200:203], v[56:59]
    v_mfma_f32_16x16x32_bf16 v[60:63], a[188:191], v[208:211], 0
    v_mfma_f32_16x16x32_bf16 v[60:63], a[220:223], v[200:203], v[60:63]
    v_mfma_f32_16x16x32_bf16 a[228:231], a[248:251], v[208:211], 0
    v_mfma_f32_16x16x32_bf16 a[228:231], a[248:251], v[200:203], a[228:231]
    s_cmp_lt_u32 s55, 6
    s_cbranch_scc1 L_bw6
    s_waitcnt vmcnt(2)
L_bw6:
    s_mov_b32 m0, s36
    s_nop 0
    buffer_load_dwordx4 v251, s[16:19], s37 offen nt lds
    buffer_load_dwordx4 v251, s[16:19], s37 offen offset:1024 nt lds
    s_add_u32 s36, s36, 0x800
    s_add_u32 s37, s37, 0x800
    v_xor_b32 v251, 32, v251
    s_mov_b32 m0, s36
    s_nop 0
    buffer_load_dwordx4 v251, s[16:19], s37 offen nt lds
    buffer_load_dwordx4 v251, s[16:19], s37 offen offset:1024 nt lds
    s_add_u32 s36, s36, 0x800
    s_add_u32 s37, s37, 0x800
    v_xor_b32 v251, 32, v251
    s_waitcnt vmcnt(10)
    ds_read_b128 a[32:35], v248 offset:8192
    ds_read_b128 a[36:39], v248 offset:8448
    ds_read_b128 a[40:43], v248 offset:8704
    ds_read_b128 a[44:47], v248 offset:8960
    s_waitcnt lgkmcnt(0)
    v_mfma_f32_16x16x32_bf16 v[208:211], a[96:99], a[32:35], 0
    v_mfma_f32_16x16x32_bf16 v[208:211], a[100:103], a[36:39], v[208:211]
    v_mfma_f32_16x16x32_bf16 v[208:211], a[104:107], a[40:43], v[208:211]
    v_mfma_f32_16x16x32_bf16 v[208:211], a[108:111], a[44:47], v[208:211]
    v_mfma_f32_16x16x32_bf16 v[212:215], a[112:115], a[32:35], 0
    v_mfma_f32_16x16x32_bf16 v[212:215], a[116:119], a[36:39], v[212:215]
    v_mfma_f32_16x16x32_bf16 v[212:215], a[120:123], a[40:43], v[212:215]
    v_mfma_f32_16x16x32_bf16 v[212:215], a[124:127], a[44:47], v[212:215]
    s_nop 0
    v_mfma_f32_16x16x32_bf16 v[192:195], a[128:131], a[32:35], 0
    s_nop 0
    v_mfma_f32_16x16x32_bf16 v[192:195], a[132:135], a[36:39], v[192:195]
    s_nop 0
    v_mfma_f32_16x16x32_bf16 v[192:195], a[136:139], a[40:43], v[192:195]
    s_nop 0
    v_max3_f32 v218, v208, v209, v210
    v_max3_f32 v218, v218, v211, v212
    v_mfma_f32_16x16x32_bf16 v[192:195], a[140:143], a[44:47], v[192:195]
    v_max3_f32 v218, v218, v213, v214
    v_max_f32 v218, v218, v215
    v_mfma_f32_16x16x32_bf16 v[196:199], a[144:147], a[32:35], 0
    v_mov_b32 v252, v218
    v_mfma_f32_16x16x32_bf16 v[196:199], a[148:151], a[36:39], v[196:199]
    s_nop 0
    v_permlane16_swap_b32 v252, v218
    v_max_f32 v218, v218, v252
    v_mov_b32 v252, v218
    v_mfma_f32_16x16x32_bf16 v[196:199], a[152:155], a[40:43], v[196:199]
    s_nop 0
    v_permlane32_swap_b32 v252, v218
    v_max_f32 v218, v218, v252
    v_mul_f32 v218, s33, v218
    v_mfma_f32_16x16x32_bf16 v[196:199], a[156:159], a[44:47], v[196:199]
    v_fma_f32 v208, v208, s32, v218
    v_exp_f32 v208, v208
    v_fma_f32 v209, v209, s32, v218
    v_fma_f32 v210, v210, s32, v218
    v_exp_f32 v209, v209
    v_exp_f32 v210, v210
    v_fma_f32 v211, v211, s32, v218
    v_exp_f32 v211, v211
    v_cvt_pk_bf16_f32 v208, v208, v209
    v_cvt_pk_bf16_f32 v209, v210, v211
    v_fma_f32 v212, v212, s32, v218
    v_exp_f32 v212, v212
    v_fma_f32 v213, v213, s32, v218
    v_fma_f32 v192, v192, s32, v218
    v_exp_f32 v213, v213
    v_exp_f32 v192, v192
    v_fma_f32 v214, v214, s32, v218
    v_fma_f32 v193, v193, s32, v218
    v_fma_f32 v215, v215, s32, v218
    v_cvt_pk_bf16_f32 v210, v212, v213
    v_exp_f32 v214, v214
    v_exp_f32 v193, v193
    v_exp_f32 v215, v215
    v_fma_f32 v194, v194, s32, v218
    v_cvt_pk_bf16_f32 v192, v192, v193
    v_exp_f32 v194, v194
    v_fma_f32 v195, v195, s32, v218
    v_exp_f32 v195, v195
    v_fma_f32 v196, v196, s32, v218
    v_fma_f32 v197, v197, s32, v218
    v_exp_f32 v196, v196
    v_exp_f32 v197, v197
    v_fma_f32 v198, v198, s32, v218
    v_exp_f32 v198, v198
    v_fma_f32 v199, v199, s32, v218
    v_exp_f32 v199, v199
    v_cvt_pk_bf16_f32 v211, v214, v215
    v_cvt_pk_bf16_f32 v193, v194, v195
    v_cvt_pk_bf16_f32 v194, v196, v197
    v_cvt_pk_bf16_f32 v195, v198, v199
    v_mfma_f32_16x16x32_bf16 v[64:67], a[160:163], v[208:211], 0
    s_nop 0
    v_mfma_f32_16x16x32_bf16 v[64:67], a[192:195], v[192:195], v[64:67]
    v_mfma_f32_16x16x32_bf16 v[68:71], a[164:167], v[208:211], 0
    v_mfma_f32_16x16x32_bf16 v[68:71], a[196:199], v[192:195], v[68:71]
    v_mfma_f32_16x16x32_bf16 v[72:75], a[168:171], v[208:211], 0
    v_mfma_f32_16x16x32_bf16 v[72:75], a[200:203], v[192:195], v[72:75]
    v_mfma_f32_16x16x32_bf16 v[76:79], a[172:175], v[208:211], 0
    v_mfma_f32_16x16x32_bf16 v[76:79], a[204:207], v[192:195], v[76:79]
    v_mfma_f32_16x16x32_bf16 v[80:83], a[176:179], v[208:211], 0
    v_mfma_f32_16x16x32_bf16 v[80:83], a[208:211], v[192:195], v[80:83]
    v_mfma_f32_16x16x32_bf16 v[84:87], a[180:183], v[208:211], 0
    v_mfma_f32_16x16x32_bf16 v[84:87], a[212:215], v[192:195], v[84:87]
    v_mfma_f32_16x16x32_bf16 v[88:91], a[184:187], v[208:211], 0
    v_mfma_f32_16x16x32_bf16 v[88:91], a[216:219], v[192:195], v[88:91]
    v_mfma_f32_16x16x32_bf16 v[92:95], a[188:191], v[208:211], 0
    v_mfma_f32_16x16x32_bf16 v[92:95], a[220:223], v[192:195], v[92:95]
    v_mfma_f32_16x16x32_bf16 a[232:235], a[248:251], v[208:211], 0
    v_mfma_f32_16x16x32_bf16 a[232:235], a[248:251], v[192:195], a[232:235]
    s_cmp_lt_u32 s55, 7
    s_cbranch_scc1 L_bw7
    s_waitcnt vmcnt(2)
L_bw7:
    s_mov_b32 m0, s36
    s_nop 0
    buffer_load_dwordx4 v251, s[16:19], s37 offen nt lds
    buffer_load_dwordx4 v251, s[16:19], s37 offen offset:1024 nt lds
    s_add_u32 s36, s36, 0x800
    s_add_u32 s37, s37, 0x800
    v_xor_b32 v251, 32, v251
    s_add_u32 m0, s6, 0x4000
    s_mov_b32 s34, 0x4000
    buffer_load_dwordx4 v249, s[8:11], s34 offen nt lds
    buffer_load_dwordx4 v249, s[8:11], s34 offen offset:1024 nt lds
    s_waitcnt vmcnt(10)
    ds_read_b128 a[48:51], v248 offset:12288
    ds_read_b128 a[52:55], v248 offset:12544
    ds_read_b128 a[56:59], v248 offset:12800
    ds_read_b128 a[60:63], v248 offset:13056
    s_waitcnt lgkmcnt(0)
    v_mfma_f32_16x16x32_bf16 v[208:211], a[96:99], a[48:51], 0
    v_mfma_f32_16x16x32_bf16 v[208:211], a[100:103], a[52:55], v[208:211]
    v_mfma_f32_16x16x32_bf16 v[208:211], a[104:107], a[56:59], v[208:211]
    v_mfma_f32_16x16x32_bf16 v[208:211], a[108:111], a[60:63], v[208:211]
    v_mfma_f32_16x16x32_bf16 v[212:215], a[112:115], a[48:51], 0
    v_mfma_f32_16x16x32_bf16 v[212:215], a[116:119], a[52:55], v[212:215]
    v_mfma_f32_16x16x32_bf16 v[212:215], a[120:123], a[56:59], v[212:215]
    v_mfma_f32_16x16x32_bf16 v[212:215], a[124:127], a[60:63], v[212:215]
    s_nop 0
    v_mfma_f32_16x16x32_bf16 v[200:203], a[128:131], a[48:51], 0
    s_nop 0
    v_mfma_f32_16x16x32_bf16 v[200:203], a[132:135], a[52:55], v[200:203]
    s_nop 0
    v_mfma_f32_16x16x32_bf16 v[200:203], a[136:139], a[56:59], v[200:203]
    s_nop 0
    v_max3_f32 v219, v208, v209, v210
    v_max3_f32 v219, v219, v211, v212
    v_mfma_f32_16x16x32_bf16 v[200:203], a[140:143], a[60:63], v[200:203]
    v_max3_f32 v219, v219, v213, v214
    v_max_f32 v219, v219, v215
    v_mfma_f32_16x16x32_bf16 v[204:207], a[144:147], a[48:51], 0
    v_mov_b32 v252, v219
    v_mfma_f32_16x16x32_bf16 v[204:207], a[148:151], a[52:55], v[204:207]
    s_nop 0
    v_permlane16_swap_b32 v252, v219
    v_max_f32 v219, v219, v252
    v_mov_b32 v252, v219
    v_mfma_f32_16x16x32_bf16 v[204:207], a[152:155], a[56:59], v[204:207]
    s_nop 0
    v_permlane32_swap_b32 v252, v219
    v_max_f32 v219, v219, v252
    v_mul_f32 v219, s33, v219
    v_mfma_f32_16x16x32_bf16 v[204:207], a[156:159], a[60:63], v[204:207]
    v_fma_f32 v208, v208, s32, v219
    v_exp_f32 v208, v208
    v_fma_f32 v209, v209, s32, v219
    v_fma_f32 v210, v210, s32, v219
    v_exp_f32 v209, v209
    v_exp_f32 v210, v210
    v_fma_f32 v211, v211, s32, v219
    v_exp_f32 v211, v211
    v_cvt_pk_bf16_f32 v208, v208, v209
    v_cvt_pk_bf16_f32 v209, v210, v211
    v_fma_f32 v212, v212, s32, v219
    v_exp_f32 v212, v212
    v_fma_f32 v213, v213, s32, v219
    v_fma_f32 v200, v200, s32, v219
    v_exp_f32 v213, v213
    v_exp_f32 v200, v200
    v_fma_f32 v214, v214, s32, v219
    v_fma_f32 v201, v201, s32, v219
    v_fma_f32 v215, v215, s32, v219
    v_cvt_pk_bf16_f32 v210, v212, v213
    v_exp_f32 v214, v214
    v_exp_f32 v201, v201
    v_exp_f32 v215, v215
    v_fma_f32 v202, v202, s32, v219
    v_cvt_pk_bf16_f32 v200, v200, v201
    v_exp_f32 v202, v202
    v_fma_f32 v203, v203, s32, v219
    v_exp_f32 v203, v203
    v_fma_f32 v204, v204, s32, v219
    v_fma_f32 v205, v205, s32, v219
    v_exp_f32 v204, v204
    v_exp_f32 v205, v205
    v_fma_f32 v206, v206, s32, v219
    v_exp_f32 v206, v206
    v_fma_f32 v207, v207, s32, v219
    v_exp_f32 v207, v207
    v_cvt_pk_bf16_f32 v211, v214, v215
    v_cvt_pk_bf16_f32 v201, v202, v203
    v_cvt_pk_bf16_f32 v202, v204, v205
    v_cvt_pk_bf16_f32 v203, v206, v207
    v_mfma_f32_16x16x32_bf16 v[96:99], a[160:163], v[208:211], 0
    s_nop 0
    v_mfma_f32_16x16x32_bf16 v[96:99], a[192:195], v[200:203], v[96:99]
    v_mfma_f32_16x16x32_bf16 v[100:103], a[164:167], v[208:211], 0
    v_mfma_f32_16x16x32_bf16 v[100:103], a[196:199], v[200:203], v[100:103]
    v_mfma_f32_16x16x32_bf16 v[104:107], a[168:171], v[208:211], 0
    v_mfma_f32_16x16x32_bf16 v[104:107], a[200:203], v[200:203], v[104:107]
    v_mfma_f32_16x16x32_bf16 v[108:111], a[172:175], v[208:211], 0
    v_mfma_f32_16x16x32_bf16 v[108:111], a[204:207], v[200:203], v[108:111]
    v_mfma_f32_16x16x32_bf16 v[112:115], a[176:179], v[208:211], 0
    v_mfma_f32_16x16x32_bf16 v[112:115], a[208:211], v[200:203], v[112:115]
    v_mfma_f32_16x16x32_bf16 v[116:119], a[180:183], v[208:211], 0
    v_mfma_f32_16x16x32_bf16 v[116:119], a[212:215], v[200:203], v[116:119]
    v_mfma_f32_16x16x32_bf16 v[120:123], a[184:187], v[208:211], 0
    v_mfma_f32_16x16x32_bf16 v[120:123], a[216:219], v[200:203], v[120:123]
    v_mfma_f32_16x16x32_bf16 v[124:127], a[188:191], v[208:211], 0
    v_mfma_f32_16x16x32_bf16 v[124:127], a[220:223], v[200:203], v[124:127]
    v_mfma_f32_16x16x32_bf16 a[236:239], a[248:251], v[208:211], 0
    v_mfma_f32_16x16x32_bf16 a[236:239], a[248:251], v[200:203], a[236:239]
    s_add_u32 m0, s6, 0xc000
    s_mov_b32 s34, 0x4000
    buffer_load_dwordx4 v250, s[12:15], s34 offen nt lds
    buffer_load_dwordx4 v250, s[12:15], s34 offen offset:1024 nt lds
    s_add_u32 m0, s6, 0x6000
    s_mov_b32 s34, 0x6000
    buffer_load_dwordx4 v249, s[8:11], s34 offen nt lds
    buffer_load_dwordx4 v249, s[8:11], s34 offen offset:1024 nt lds
    s_waitcnt vmcnt(10)
    ds_read_b128 a[64:67], v248 offset:16384
    ds_read_b128 a[68:71], v248 offset:16640
    ds_read_b128 a[72:75], v248 offset:16896
    ds_read_b128 a[76:79], v248 offset:17152
    s_waitcnt lgkmcnt(0)
    v_mfma_f32_16x16x32_bf16 v[208:211], a[96:99], a[64:67], 0
    v_mfma_f32_16x16x32_bf16 v[208:211], a[100:103], a[68:71], v[208:211]
    v_mfma_f32_16x16x32_bf16 v[208:211], a[104:107], a[72:75], v[208:211]
    v_mfma_f32_16x16x32_bf16 v[208:211], a[108:111], a[76:79], v[208:211]
    v_mfma_f32_16x16x32_bf16 v[212:215], a[112:115], a[64:67], 0
    v_mfma_f32_16x16x32_bf16 v[212:215], a[116:119], a[68:71], v[212:215]
    v_mfma_f32_16x16x32_bf16 v[212:215], a[120:123], a[72:75], v[212:215]
    v_mfma_f32_16x16x32_bf16 v[212:215], a[124:127], a[76:79], v[212:215]
    s_nop 0
    v_mfma_f32_16x16x32_bf16 v[192:195], a[128:131], a[64:67], 0
    s_nop 0
    v_mfma_f32_16x16x32_bf16 v[192:195], a[132:135], a[68:71], v[192:195]
    s_nop 0
    v_mfma_f32_16x16x32_bf16 v[192:195], a[136:139], a[72:75], v[192:195]
    s_nop 0
    v_max3_f32 v220, v208, v209, v210
    v_max3_f32 v220, v220, v211, v212
    v_mfma_f32_16x16x32_bf16 v[192:195], a[140:143], a[76:79], v[192:195]
    v_max3_f32 v220, v220, v213, v214
    v_max_f32 v220, v220, v215
    v_mfma_f32_16x16x32_bf16 v[196:199], a[144:147], a[64:67], 0
    v_mov_b32 v252, v220
    v_mfma_f32_16x16x32_bf16 v[196:199], a[148:151], a[68:71], v[196:199]
    s_nop 0
    v_permlane16_swap_b32 v252, v220
    v_max_f32 v220, v220, v252
    v_mov_b32 v252, v220
    v_mfma_f32_16x16x32_bf16 v[196:199], a[152:155], a[72:75], v[196:199]
    s_nop 0
    v_permlane32_swap_b32 v252, v220
    v_max_f32 v220, v220, v252
    v_mul_f32 v220, s33, v220
    v_mfma_f32_16x16x32_bf16 v[196:199], a[156:159], a[76:79], v[196:199]
    v_fma_f32 v208, v208, s32, v220
    v_exp_f32 v208, v208
    v_fma_f32 v209, v209, s32, v220
    v_fma_f32 v210, v210, s32, v220
    v_exp_f32 v209, v209
    v_exp_f32 v210, v210
    v_fma_f32 v211, v211, s32, v220
    v_exp_f32 v211, v211
    v_cvt_pk_bf16_f32 v208, v208, v209
    v_cvt_pk_bf16_f32 v209, v210, v211
    v_fma_f32 v212, v212, s32, v220
    v_exp_f32 v212, v212
    v_fma_f32 v213, v213, s32, v220
    v_fma_f32 v192, v192, s32, v220
    v_exp_f32 v213, v213
    v_exp_f32 v192, v192
    v_fma_f32 v214, v214, s32, v220
    v_fma_f32 v193, v193, s32, v220
    v_fma_f32 v215, v215, s32, v220
    v_cvt_pk_bf16_f32 v210, v212, v213
    v_exp_f32 v214, v214
    v_exp_f32 v193, v193
    v_exp_f32 v215, v215
    v_fma_f32 v194, v194, s32, v220
    v_cvt_pk_bf16_f32 v192, v192, v193
    v_exp_f32 v194, v194
    v_fma_f32 v195, v195, s32, v220
    v_exp_f32 v195, v195
    v_fma_f32 v196, v196, s32, v220
    v_fma_f32 v197, v197, s32, v220
    v_exp_f32 v196, v196
    v_exp_f32 v197, v197
    v_fma_f32 v198, v198, s32, v220
    v_exp_f32 v198, v198
    v_fma_f32 v199, v199, s32, v220
    v_exp_f32 v199, v199
    v_cvt_pk_bf16_f32 v211, v214, v215
    v_cvt_pk_bf16_f32 v193, v194, v195
    v_cvt_pk_bf16_f32 v194, v196, v197
    v_cvt_pk_bf16_f32 v195, v198, v199
    v_mfma_f32_16x16x32_bf16 v[128:131], a[160:163], v[208:211], 0
    s_nop 0
    v_mfma_f32_16x16x32_bf16 v[128:131], a[192:195], v[192:195], v[128:131]
    v_mfma_f32_16x16x32_bf16 v[132:135], a[164:167], v[208:211], 0
    v_mfma_f32_16x16x32_bf16 v[132:135], a[196:199], v[192:195], v[132:135]
    v_mfma_f32_16x16x32_bf16 v[136:139], a[168:171], v[208:211], 0
    v_mfma_f32_16x16x32_bf16 v[136:139], a[200:203], v[192:195], v[136:139]
    v_mfma_f32_16x16x32_bf16 v[140:143], a[172:175], v[208:211], 0
    v_mfma_f32_16x16x32_bf16 v[140:143], a[204:207], v[192:195], v[140:143]
    v_mfma_f32_16x16x32_bf16 v[144:147], a[176:179], v[208:211], 0
    v_mfma_f32_16x16x32_bf16 v[144:147], a[208:211], v[192:195], v[144:147]
    v_mfma_f32_16x16x32_bf16 v[148:151], a[180:183], v[208:211], 0
    v_mfma_f32_16x16x32_bf16 v[148:151], a[212:215], v[192:195], v[148:151]
    v_mfma_f32_16x16x32_bf16 v[152:155], a[184:187], v[208:211], 0
    v_mfma_f32_16x16x32_bf16 v[152:155], a[216:219], v[192:195], v[152:155]
    v_mfma_f32_16x16x32_bf16 v[156:159], a[188:191], v[208:211], 0
    v_mfma_f32_16x16x32_bf16 v[156:159], a[220:223], v[192:195], v[156:159]
    v_mfma_f32_16x16x32_bf16 a[240:243], a[248:251], v[208:211], 0
    v_mfma_f32_16x16x32_bf16 a[240:243], a[248:251], v[192:195], a[240:243]
    s_add_u32 m0, s6, 0xe000
    s_mov_b32 s34, 0x6000
    buffer_load_dwordx4 v250, s[12:15], s34 offen nt lds
    buffer_load_dwordx4 v250, s[12:15], s34 offen offset:1024 nt lds
    s_add_u32 m0, s6, 0x0
    s_mov_b32 s34, 0x8000
    buffer_load_dwordx4 v249, s[8:11], s34 offen nt lds
    buffer_load_dwordx4 v249, s[8:11], s34 offen offset:1024 nt lds
    s_waitcnt vmcnt(10)
    ds_read_b128 a[80:83], v248 offset:20480
    ds_read_b128 a[84:87], v248 offset:20736
    ds_read_b128 a[88:91], v248 offset:20992
    ds_read_b128 a[92:95], v248 offset:21248
    s_waitcnt lgkmcnt(0)
    v_mfma_f32_16x16x32_bf16 v[208:211], a[96:99], a[80:83], 0
    v_mfma_f32_16x16x32_bf16 v[208:211], a[100:103], a[84:87], v[208:211]
    v_mfma_f32_16x16x32_bf16 v[208:211], a[104:107], a[88:91], v[208:211]
    v_mfma_f32_16x16x32_bf16 v[208:211], a[108:111], a[92:95], v[208:211]
    v_mfma_f32_16x16x32_bf16 v[212:215], a[112:115], a[80:83], 0
    v_mfma_f32_16x16x32_bf16 v[212:215], a[116:119], a[84:87], v[212:215]
    v_mfma_f32_16x16x32_bf16 v[212:215], a[120:123], a[88:91], v[212:215]
    v_mfma_f32_16x16x32_bf16 v[212:215], a[124:127], a[92:95], v[212:215]
    v_mfma_f32_16x16x32_bf16 v[200:203], a[128:131], a[80:83], 0
    v_mfma_f32_16x16x32_bf16 v[200:203], a[132:135], a[84:87], v[200:203]
    s_add_u32 m0, s6, 0x8000
    s_mov_b32 s34, 0x8000
    buffer_load_dwordx4 v250, s[12:15], s34 offen nt lds
    buffer_load_dwordx4 v250, s[12:15], s34 offen offset:1024 nt lds
    s_waitcnt vmcnt(10)
    s_barrier
    v_mfma_f32_16x16x32_bf16 v[200:203], a[136:139], a[88:91], v[200:203]
    v_max3_f32 v221, v208, v209, v210
    v_max3_f32 v221, v221, v211, v212
    v_mfma_f32_16x16x32_bf16 v[200:203], a[140:143], a[92:95], v[200:203]
    v_max3_f32 v221, v221, v213, v214
    v_max_f32 v221, v221, v215
    v_mfma_f32_16x16x32_bf16 v[204:207], a[144:147], a[80:83], 0
    ds_read_b128 a[96:99], v222 offset:0
    v_mov_b32 v252, v221
    v_mfma_f32_16x16x32_bf16 v[204:207], a[148:151], a[84:87], v[204:207]
    s_nop 0
    v_permlane16_swap_b32 v252, v221
    v_mfma_f32_16x16x32_bf16 v[204:207], a[152:155], a[88:91], v[204:207]
    v_max_f32 v221, v221, v252
    v_mov_b32 v252, v221
    v_mfma_f32_16x16x32_bf16 v[204:207], a[156:159], a[92:95], v[204:207]
    s_nop 0
    v_permlane32_swap_b32 v252, v221
    v_max_f32 v221, v221, v252
    v_mul_f32 v221, s33, v221
    v_fma_f32 v208, v208, s32, v221
    v_exp_f32 v208, v208
    ds_read_b128 a[100:103], v222 offset:256
    v_fma_f32 v209, v209, s32, v221
    v_exp_f32 v209, v209
    v_fma_f32 v210, v210, s32, v221
    ds_read_b128 a[104:107], v222 offset:512
    v_cvt_pk_bf16_f32 v208, v208, v209
    v_exp_f32 v210, v210
    v_fma_f32 v211, v211, s32, v221
    ds_read_b128 a[108:111], v222 offset:768
    v_exp_f32 v211, v211
    v_fma_f32 v212, v212, s32, v221
    v_fma_f32 v213, v213, s32, v221
    ds_read_b128 a[112:115], v222 offset:1024
    v_cvt_pk_bf16_f32 v209, v210, v211
    v_exp_f32 v212, v212
    v_fma_f32 v214, v214, s32, v221
    v_exp_f32 v213, v213
    v_exp_f32 v214, v214
    v_fma_f32 v215, v215, s32, v221
    v_exp_f32 v215, v215
    ds_read_b128 a[116:119], v222 offset:1280
    v_cvt_pk_bf16_f32 v210, v212, v213
    v_cvt_pk_bf16_f32 v211, v214, v215
    v_fma_f32 v200, v200, s32, v221
    ds_read_b128 a[120:123], v222 offset:1536
    v_exp_f32 v200, v200
    v_fma_f32 v201, v201, s32, v221
    v_mfma_f32_16x16x32_bf16 v[160:163], a[160:163], v[208:211], 0
    ds_read_b128 a[124:127], v222 offset:1792
    v_fma_f32 v202, v202, s32, v221
    v_mfma_f32_16x16x32_bf16 v[164:167], a[164:167], v[208:211], 0
    v_exp_f32 v201, v201
    v_mfma_f32_16x16x32_bf16 v[168:171], a[168:171], v[208:211], 0
    v_cvt_pk_bf16_f32 v200, v200, v201
    v_fma_f32 v203, v203, s32, v221
    v_mfma_f32_16x16x32_bf16 v[172:175], a[172:175], v[208:211], 0
    v_exp_f32 v202, v202
    v_mfma_f32_16x16x32_bf16 v[176:179], a[176:179], v[208:211], 0
    v_exp_f32 v203, v203
    v_mfma_f32_16x16x32_bf16 v[180:183], a[180:183], v[208:211], 0
    v_cvt_pk_bf16_f32 v201, v202, v203
    v_fma_f32 v204, v204, s32, v221
    v_mfma_f32_16x16x32_bf16 v[184:187], a[184:187], v[208:211], 0
    v_exp_f32 v204, v204
    v_mfma_f32_16x16x32_bf16 v[188:191], a[188:191], v[208:211], 0
    v_fma_f32 v205, v205, s32, v221
    v_mfma_f32_16x16x32_bf16 a[244:247], a[248:251], v[208:211], 0
    s_waitcnt lgkmcnt(0)
    v_exp_f32 v205, v205
    v_mfma_f32_16x16x32_bf16 v[192:195], a[96:99], a[0:3], 0
    v_cvt_pk_bf16_f32 v202, v204, v205
    v_fma_f32 v206, v206, s32, v221
    v_mfma_f32_16x16x32_bf16 v[192:195], a[100:103], a[4:7], v[192:195]
    s_add_u32 m0, s6, 0x2000
    s_mov_b32 s34, 0xa000
    buffer_load_dwordx4 v249, s[8:11], s34 offen nt lds
    buffer_load_dwordx4 v249, s[8:11], s34 offen offset:1024 nt lds
    s_waitcnt vmcnt(10)
    s_barrier
    v_mfma_f32_16x16x32_bf16 v[192:195], a[104:107], a[8:11], v[192:195]
    ds_read_b64_tr_b16 a[160:161], v223 offset:0
    ds_read_b64_tr_b16 a[162:163], v223 offset:1024
    v_mfma_f32_16x16x32_bf16 v[192:195], a[108:111], a[12:15], v[192:195]
    v_exp_f32 v206, v206
    v_mfma_f32_16x16x32_bf16 v[196:199], a[112:115], a[0:3], 0
    ds_read_b64_tr_b16 a[164:165], v224 offset:0
    v_fma_f32 v207, v207, s32, v221
    v_mfma_f32_16x16x32_bf16 v[196:199], a[116:119], a[4:7], v[196:199]
    v_exp_f32 v207, v207
    v_mfma_f32_16x16x32_bf16 v[196:199], a[120:123], a[8:11], v[196:199]
    ds_read_b64_tr_b16 a[166:167], v224 offset:1024
    v_cvt_pk_bf16_f32 v203, v206, v207
    v_mfma_f32_16x16x32_bf16 v[196:199], a[124:127], a[12:15], v[196:199]
    ds_read_b64_tr_b16 a[168:169], v223 offset:256
    v_fma_f32 v192, v192, s32, v216
    v_mfma_f32_16x16x32_bf16 v[160:163], a[192:195], v[200:203], v[160:163]
    ds_read_b64_tr_b16 a[170:171], v223 offset:1280
    ds_read_b64_tr_b16 a[172:173], v224 offset:256
    v_mfma_f32_16x16x32_bf16 v[164:167], a[196:199], v[200:203], v[164:167]
    v_exp_f32 v192, v192
    v_mfma_f32_16x16x32_bf16 v[168:171], a[200:203], v[200:203], v[168:171]
    ds_read_b64_tr_b16 a[174:175], v224 offset:1280
    v_fma_f32 v193, v193, s32, v216
    v_mfma_f32_16x16x32_bf16 v[172:175], a[204:207], v[200:203], v[172:175]
    v_exp_f32 v193, v193
    v_mfma_f32_16x16x32_bf16 v[176:179], a[208:211], v[200:203], v[176:179]
    ds_read_b64_tr_b16 a[176:177], v223 offset:512
    v_cvt_pk_bf16_f32 v192, v192, v193
    v_mfma_f32_16x16x32_bf16 v[180:183], a[212:215], v[200:203], v[180:183]
    ds_read_b64_tr_b16 a[178:179], v223 offset:1536
    v_fma_f32 v194, v194, s32, v216
    v_mfma_f32_16x16x32_bf16 v[184:187], a[216:219], v[200:203], v[184:187]
    v_exp_f32 v194, v194
    v_mfma_f32_16x16x32_bf16 v[188:191], a[220:223], v[200:203], v[188:191]
    ds_read_b64_tr_b16 a[180:181], v224 offset:512
    v_fma_f32 v195, v195, s32, v216
    v_mfma_f32_16x16x32_bf16 a[244:247], a[248:251], v[200:203], a[244:247]
    ds_read_b64_tr_b16 a[182:183], v224 offset:1536
    ds_read_b64_tr_b16 a[184:185], v223 offset:768
    v_mfma_f32_16x16x32_bf16 v[200:203], a[96:99], a[16:19], 0
    v_exp_f32 v195, v195
    v_mfma_f32_16x16x32_bf16 v[200:203], a[100:103], a[20:23], v[200:203]
    v_cvt_pk_bf16_f32 v193, v194, v195
    v_fma_f32 v196, v196, s32, v216
    v_mfma_f32_16x16x32_bf16 v[200:203], a[104:107], a[24:27], v[200:203]
    ds_read_b64_tr_b16 a[186:187], v223 offset:1792
    v_exp_f32 v196, v196
    v_mfma_f32_16x16x32_bf16 v[200:203], a[108:111], a[28:31], v[200:203]
    ds_read_b64_tr_b16 a[188:189], v224 offset:768
    ds_read_b64_tr_b16 a[190:191], v224 offset:1792
    v_fma_f32 v197, v197, s32, v216
    v_mfma_f32_16x16x32_bf16 v[204:207], a[112:115], a[16:19], 0
    v_exp_f32 v197, v197
    v_fma_f32 v198, v198, s32, v216
    v_mfma_f32_16x16x32_bf16 v[204:207], a[116:119], a[20:23], v[204:207]
    v_exp_f32 v198, v198
    v_fma_f32 v199, v199, s32, v216
    v_exp_f32 v199, v199
    v_mfma_f32_16x16x32_bf16 v[204:207], a[120:123], a[24:27], v[204:207]
    v_cvt_pk_bf16_f32 v194, v196, v197
    v_cvt_pk_bf16_f32 v195, v198, v199
    v_mfma_f32_16x16x32_bf16 v[204:207], a[124:127], a[28:31], v[204:207]
    s_waitcnt lgkmcnt(0)
    v_fma_f32 v200, v200, s32, v217
    v_fma_f32 v201, v201, s32, v217
    v_mfma_f32_16x16x32_bf16 v[0:3], a[160:163], v[192:195], v[0:3]
    v_exp_f32 v200, v200
    v_mfma_f32_16x16x32_bf16 v[4:7], a[164:167], v[192:195], v[4:7]
    v_exp_f32 v201, v201
    v_mfma_f32_16x16x32_bf16 v[8:11], a[168:171], v[192:195], v[8:11]
    v_cvt_pk_bf16_f32 v200, v200, v201
    v_fma_f32 v202, v202, s32, v217
    v_mfma_f32_16x16x32_bf16 v[12:15], a[172:175], v[192:195], v[12:15]
    v_exp_f32 v202, v202
    v_mfma_f32_16x16x32_bf16 v[16:19], a[176:179], v[192:195], v[16:19]
    v_fma_f32 v203, v203, s32, v217
    v_mfma_f32_16x16x32_bf16 v[20:23], a[180:183], v[192:195], v[20:23]
    v_exp_f32 v203, v203
    v_mfma_f32_16x16x32_bf16 v[24:27], a[184:187], v[192:195], v[24:27]
    v_cvt_pk_bf16_f32 v201, v202, v203
    v_fma_f32 v204, v204, s32, v217
    v_mfma_f32_16x16x32_bf16 v[28:31], a[188:191], v[192:195], v[28:31]
    v_exp_f32 v204, v204
    v_mfma_f32_16x16x32_bf16 a[224:227], a[248:251], v[192:195], a[224:227]
    v_fma_f32 v205, v205, s32, v217
    v_mfma_f32_16x16x32_bf16 v[192:195], a[96:99], a[32:35], 0
    v_exp_f32 v205, v205
    v_mfma_f32_16x16x32_bf16 v[192:195], a[100:103], a[36:39], v[192:195]
    v_cvt_pk_bf16_f32 v202, v204, v205
    v_fma_f32 v206, v206, s32, v217
    v_mfma_f32_16x16x32_bf16 v[192:195], a[104:107], a[40:43], v[192:195]
    v_exp_f32 v206, v206
    v_mfma_f32_16x16x32_bf16 v[192:195], a[108:111], a[44:47], v[192:195]
    v_fma_f32 v207, v207, s32, v217
    v_mfma_f32_16x16x32_bf16 v[196:199], a[112:115], a[32:35], 0
    v_exp_f32 v207, v207
    v_mfma_f32_16x16x32_bf16 v[196:199], a[116:119], a[36:39], v[196:199]
    v_cvt_pk_bf16_f32 v203, v206, v207
    v_mfma_f32_16x16x32_bf16 v[196:199], a[120:123], a[40:43], v[196:199]
    v_mfma_f32_16x16x32_bf16 v[196:199], a[124:127], a[44:47], v[196:199]
    s_nop 0
    v_fma_f32 v192, v192, s32, v218
    v_fma_f32 v193, v193, s32, v218
    v_mfma_f32_16x16x32_bf16 v[32:35], a[160:163], v[200:203], v[32:35]
    v_exp_f32 v192, v192
    v_mfma_f32_16x16x32_bf16 v[36:39], a[164:167], v[200:203], v[36:39]
    v_exp_f32 v193, v193
    v_mfma_f32_16x16x32_bf16 v[40:43], a[168:171], v[200:203], v[40:43]
    s_add_u32 m0, s6, 0xa000
    s_mov_b32 s34, 0xa000
    buffer_load_dwordx4 v250, s[12:15], s34 offen nt lds
    buffer_load_dwordx4 v250, s[12:15], s34 offen offset:1024 nt lds
    s_waitcnt vmcnt(10)
    s_barrier
    v_mfma_f32_16x16x32_bf16 v[44:47], a[172:175], v[200:203], v[44:47]
    v_cvt_pk_bf16_f32 v192, v192, v193
    v_fma_f32 v194, v194, s32, v218
    v_mfma_f32_16x16x32_bf16 v[48:51], a[176:179], v[200:203], v[48:51]
    ds_read_b128 a[128:131], v222 offset:8192
    v_fma_f32 v195, v195, s32, v218
    v_mfma_f32_16x16x32_bf16 v[52:55], a[180:183], v[200:203], v[52:55]
    v_exp_f32 v194, v194
    v_mfma_f32_16x16x32_bf16 v[56:59], a[184:187], v[200:203], v[56:59]
    v_exp_f32 v195, v195
    v_mfma_f32_16x16x32_bf16 v[60:63], a[188:191], v[200:203], v[60:63]
    ds_read_b128 a[132:135], v222 offset:8448
    v_cvt_pk_bf16_f32 v193, v194, v195
    v_mfma_f32_16x16x32_bf16 a[228:231], a[248:251], v[200:203], a[228:231]
    v_fma_f32 v196, v196, s32, v218
    v_fma_f32 v197, v197, s32, v218
    v_mfma_f32_16x16x32_bf16 v[200:203], a[96:99], a[48:51], 0
    v_exp_f32 v196, v196
    v_mfma_f32_16x16x32_bf16 v[200:203], a[100:103], a[52:55], v[200:203]
    ds_read_b128 a[136:139], v222 offset:8704
    v_fma_f32 v198, v198, s32, v218
    v_mfma_f32_16x16x32_bf16 v[200:203], a[104:107], a[56:59], v[200:203]
    v_exp_f32 v197, v197
    v_mfma_f32_16x16x32_bf16 v[200:203], a[108:111], a[60:63], v[200:203]
    ds_read_b128 a[140:143], v222 offset:8960
    v_cvt_pk_bf16_f32 v194, v196, v197
    v_mfma_f32_16x16x32_bf16 v[204:207], a[112:115], a[48:51], 0
    v_exp_f32 v198, v198
    v_mfma_f32_16x16x32_bf16 v[204:207], a[116:119], a[52:55], v[204:207]
    v_fma_f32 v199, v199, s32, v218
    v_exp_f32 v199, v199
    v_mfma_f32_16x16x32_bf16 v[204:207], a[120:123], a[56:59], v[204:207]
    ds_read_b128 a[144:147], v222 offset:9216
    v_cvt_pk_bf16_f32 v195, v198, v199
    v_mfma_f32_16x16x32_bf16 v[204:207], a[124:127], a[60:63], v[204:207]
    v_fma_f32 v200, v200, s32, v219
    v_fma_f32 v201, v201, s32, v219
    v_mfma_f32_16x16x32_bf16 v[64:67], a[160:163], v[192:195], v[64:67]
    v_exp_f32 v200, v200
    v_mfma_f32_16x16x32_bf16 v[68:71], a[164:167], v[192:195], v[68:71]
    ds_read_b128 a[148:151], v222 offset:9472
    v_fma_f32 v202, v202, s32, v219
    v_mfma_f32_16x16x32_bf16 v[72:75], a[168:171], v[192:195], v[72:75]
    v_exp_f32 v201, v201
    v_mfma_f32_16x16x32_bf16 v[76:79], a[172:175], v[192:195], v[76:79]
    ds_read_b128 a[152:155], v222 offset:9728
    v_cvt_pk_bf16_f32 v200, v200, v201
    v_mfma_f32_16x16x32_bf16 v[80:83], a[176:179], v[192:195], v[80:83]
    v_exp_f32 v202, v202
    v_mfma_f32_16x16x32_bf16 v[84:87], a[180:183], v[192:195], v[84:87]
    v_fma_f32 v203, v203, s32, v219
    v_fma_f32 v204, v204, s32, v219
    v_mfma_f32_16x16x32_bf16 v[88:91], a[184:187], v[192:195], v[88:91]
    v_exp_f32 v203, v203
    v_mfma_f32_16x16x32_bf16 v[92:95], a[188:191], v[192:195], v[92:95]
    ds_read_b128 a[156:159], v222 offset:9984
    v_cvt_pk_bf16_f32 v201, v202, v203
    v_mfma_f32_16x16x32_bf16 a[232:235], a[248:251], v[192:195], a[232:235]
    v_exp_f32 v204, v204
    v_mfma_f32_16x16x32_bf16 v[192:195], a[96:99], a[64:67], 0
    v_fma_f32 v205, v205, s32, v219
    v_fma_f32 v206, v206, s32, v219
    v_mfma_f32_16x16x32_bf16 v[192:195], a[100:103], a[68:71], v[192:195]
    v_exp_f32 v205, v205
    v_mfma_f32_16x16x32_bf16 v[192:195], a[104:107], a[72:75], v[192:195]
    v_cvt_pk_bf16_f32 v202, v204, v205
    v_fma_f32 v207, v207, s32, v219
    v_mfma_f32_16x16x32_bf16 v[192:195], a[108:111], a[76:79], v[192:195]
    v_exp_f32 v206, v206
    v_mfma_f32_16x16x32_bf16 v[196:199], a[112:115], a[64:67], 0
    v_exp_f32 v207, v207
    v_mfma_f32_16x16x32_bf16 v[196:199], a[116:119], a[68:71], v[196:199]
    v_cvt_pk_bf16_f32 v203, v206, v207
    v_xor_b32 v222, 0x4000, v222
    v_mfma_f32_16x16x32_bf16 v[196:199], a[120:123], a[72:75], v[196:199]
    v_mfma_f32_16x16x32_bf16 v[196:199], a[124:127], a[76:79], v[196:199]
    v_fma_f32 v192, v192, s32, v220
    v_fma_f32 v193, v193, s32, v220
    v_mfma_f32_16x16x32_bf16 v[96:99], a[160:163], v[200:203], v[96:99]
    s_xor_b32 s35, s6, 0x4000
    s_mov_b32 s34, 0xc000
    s_mov_b32 s41, 0xc000
    s_mov_b32 s36, s7
    s_mov_b32 s37, 0x18000
    s_waitcnt vmcnt(8) lgkmcnt(0)
    s_barrier
    v_mfma_f32_16x16x32_bf16 v[100:103], a[164:167], v[200:203], v[100:103]
    v_exp_f32 v192, v192
    v_mfma_f32_16x16x32_bf16 v[104:107], a[168:171], v[200:203], v[104:107]
    ds_read_b64_tr_b16 a[192:193], v223 offset:8192
    v_fma_f32 v194, v194, s32, v220
    v_mfma_f32_16x16x32_bf16 v[108:111], a[172:175], v[200:203], v[108:111]
    v_exp_f32 v193, v193
    v_mfma_f32_16x16x32_bf16 v[112:115], a[176:179], v[200:203], v[112:115]
    ds_read_b64_tr_b16 a[194:195], v223 offset:9216
    v_cvt_pk_bf16_f32 v192, v192, v193
    v_mfma_f32_16x16x32_bf16 v[116:119], a[180:183], v[200:203], v[116:119]
    v_exp_f32 v194, v194
    v_mfma_f32_16x16x32_bf16 v[120:123], a[184:187], v[200:203], v[120:123]
    ds_read_b64_tr_b16 a[196:197], v224 offset:8192
    v_fma_f32 v195, v195, s32, v220
    v_mfma_f32_16x16x32_bf16 v[124:127], a[188:191], v[200:203], v[124:127]
    v_exp_f32 v195, v195
    v_mfma_f32_16x16x32_bf16 a[236:239], a[248:251], v[200:203], a[236:239]
    v_cvt_pk_bf16_f32 v193, v194, v195
    v_fma_f32 v196, v196, s32, v220
    v_mfma_f32_16x16x32_bf16 v[200:203], a[96:99], a[80:83], 0
    ds_read_b64_tr_b16 a[198:199], v224 offset:9216
    v_fma_f32 v197, v197, s32, v220
    v_mfma_f32_16x16x32_bf16 v[200:203], a[100:103], a[84:87], v[200:203]
    v_exp_f32 v196, v196
    v_mfma_f32_16x16x32_bf16 v[200:203], a[104:107], a[88:91], v[200:203]
    ds_read_b64_tr_b16 a[200:201], v223 offset:8448
    v_fma_f32 v198, v198, s32, v220
    v_mfma_f32_16x16x32_bf16 v[200:203], a[108:111], a[92:95], v[200:203]
    v_exp_f32 v197, v197
    v_mfma_f32_16x16x32_bf16 v[204:207], a[112:115], a[80:83], 0
    ds_read_b64_tr_b16 a[202:203], v223 offset:9472
    v_cvt_pk_bf16_f32 v194, v196, v197
    v_mfma_f32_16x16x32_bf16 v[204:207], a[116:119], a[84:87], v[204:207]
    v_exp_f32 v198, v198
    v_fma_f32 v199, v199, s32, v220
    v_exp_f32 v199, v199
    v_mfma_f32_16x16x32_bf16 v[204:207], a[120:123], a[88:91], v[204:207]
    ds_read_b64_tr_b16 a[204:205], v224 offset:8448
    v_cvt_pk_bf16_f32 v195, v198, v199
    v_mfma_f32_16x16x32_bf16 v[204:207], a[124:127], a[92:95], v[204:207]
    s_xor_b32 m0, s35, 0x8000
    ds_read_b64_tr_b16 a[206:207], v224 offset:9472
    v_fma_f32 v200, v200, s32, v221
    v_mfma_f32_16x16x32_bf16 v[128:131], a[160:163], v[192:195], v[128:131]
    v_exp_f32 v200, v200
    v_mfma_f32_16x16x32_bf16 v[132:135], a[164:167], v[192:195], v[132:135]
    buffer_load_dwordx4 v250, s[12:15], s34 offen nt lds
    v_mfma_f32_16x16x32_bf16 v[136:139], a[168:171], v[192:195], v[136:139]
    ds_read_b64_tr_b16 a[208:209], v223 offset:8704
    v_fma_f32 v201, v201, s32, v221
    v_mfma_f32_16x16x32_bf16 v[140:143], a[172:175], v[192:195], v[140:143]
    v_exp_f32 v201, v201
    v_mfma_f32_16x16x32_bf16 v[144:147], a[176:179], v[192:195], v[144:147]
    ds_read_b64_tr_b16 a[210:211], v223 offset:9728
    v_cvt_pk_bf16_f32 v200, v200, v201
    v_mfma_f32_16x16x32_bf16 v[148:151], a[180:183], v[192:195], v[148:151]
    ds_read_b64_tr_b16 a[212:213], v224 offset:8704
    v_fma_f32 v202, v202, s32, v221
    v_mfma_f32_16x16x32_bf16 v[152:155], a[184:187], v[192:195], v[152:155]
    v_exp_f32 v202, v202
    v_mfma_f32_16x16x32_bf16 v[156:159], a[188:191], v[192:195], v[156:159]
    buffer_load_dwordx4 v250, s[12:15], s34 offen offset:1024 nt lds
    v_mfma_f32_16x16x32_bf16 a[240:243], a[248:251], v[192:195], a[240:243]
    ds_read_b64_tr_b16 a[214:215], v224 offset:9728
    v_fma_f32 v203, v203, s32, v221
    v_mfma_f32_16x16x32_bf16 v[192:195], a[128:131], a[0:3], 0
    v_exp_f32 v203, v203
    v_fma_f32 v204, v204, s32, v221
    v_mfma_f32_16x16x32_bf16 v[192:195], a[132:135], a[4:7], v[192:195]
    v_cvt_pk_bf16_f32 v201, v202, v203
    v_exp_f32 v204, v204
    v_mfma_f32_16x16x32_bf16 v[192:195], a[136:139], a[8:11], v[192:195]
    s_mov_b32 m0, s35
    ds_read_b64_tr_b16 a[216:217], v223 offset:8960
    ds_read_b64_tr_b16 a[218:219], v223 offset:9984
    v_fma_f32 v205, v205, s32, v221
    v_mfma_f32_16x16x32_bf16 v[192:195], a[140:143], a[12:15], v[192:195]
    v_exp_f32 v205, v205
    v_fma_f32 v206, v206, s32, v221
    v_mfma_f32_16x16x32_bf16 v[196:199], a[144:147], a[0:3], 0
    buffer_load_dwordx4 v249, s[8:11], s34 offen nt lds
    v_mfma_f32_16x16x32_bf16 v[196:199], a[148:151], a[4:7], v[196:199]
    v_exp_f32 v206, v206
    v_fma_f32 v207, v207, s32, v221
    v_exp_f32 v207, v207
    v_mfma_f32_16x16x32_bf16 v[196:199], a[152:155], a[8:11], v[196:199]
    v_cvt_pk_bf16_f32 v202, v204, v205
    v_cvt_pk_bf16_f32 v203, v206, v207
    v_mfma_f32_16x16x32_bf16 v[196:199], a[156:159], a[12:15], v[196:199]
    ds_read_b64_tr_b16 a[220:221], v224 offset:8960
    ds_read_b64_tr_b16 a[222:223], v224 offset:9984
    v_mfma_f32_16x16x32_bf16 v[160:163], a[160:163], v[200:203], v[160:163]
    v_fma_f32 v192, v192, s32, v216
    v_fma_f32 v193, v193, s32, v216
    v_mfma_f32_16x16x32_bf16 v[164:167], a[164:167], v[200:203], v[164:167]
    v_exp_f32 v192, v192
    v_mfma_f32_16x16x32_bf16 v[168:171], a[168:171], v[200:203], v[168:171]
    buffer_load_dwordx4 v249, s[8:11], s34 offen offset:1024 nt lds
    v_mfma_f32_16x16x32_bf16 v[172:175], a[172:175], v[200:203], v[172:175]
    v_exp_f32 v193, v193
    v_mfma_f32_16x16x32_bf16 v[176:179], a[176:179], v[200:203], v[176:179]
    s_add_u32 s34, s34, 0x2000
    v_cvt_pk_bf16_f32 v192, v192, v193
    v_fma_f32 v194, v194, s32, v216
    v_mfma_f32_16x16x32_bf16 v[180:183], a[180:183], v[200:203], v[180:183]
    s_xor_b32 s35, s35, 0x2000
    v_exp_f32 v194, v194
    v_mfma_f32_16x16x32_bf16 v[184:187], a[184:187], v[200:203], v[184:187]
    v_fma_f32 v195, v195, s32, v216
    v_fma_f32 v196, v196, s32, v216
    v_mfma_f32_16x16x32_bf16 v[188:191], a[188:191], v[200:203], v[188:191]
    v_exp_f32 v195, v195
    v_mfma_f32_16x16x32_bf16 a[244:247], a[248:251], v[200:203], a[244:247]
    v_cvt_pk_bf16_f32 v193, v194, v195
    v_fma_f32 v197, v197, s32, v216
    v_mfma_f32_16x16x32_bf16 v[200:203], a[128:131], a[16:19], 0
    v_exp_f32 v196, v196
    v_mfma_f32_16x16x32_bf16 v[200:203], a[132:135], a[20:23], v[200:203]
    v_exp_f32 v197, v197
    v_mfma_f32_16x16x32_bf16 v[200:203], a[136:139], a[24:27], v[200:203]
    v_cvt_pk_bf16_f32 v194, v196, v197
    v_fma_f32 v198, v198, s32, v216
    v_mfma_f32_16x16x32_bf16 v[200:203], a[140:143], a[28:31], v[200:203]
    v_exp_f32 v198, v198
    v_fma_f32 v199, v199, s32, v216
    v_exp_f32 v199, v199
    v_mfma_f32_16x16x32_bf16 v[204:207], a[144:147], a[16:19], 0
    v_cvt_pk_bf16_f32 v195, v198, v199
    v_xor_b32 v223, 0x4000, v223
    v_xor_b32 v224, 0x4000, v224
    v_mfma_f32_16x16x32_bf16 v[204:207], a[148:151], a[20:23], v[204:207]
    s_waitcnt vmcnt(8) lgkmcnt(0)
.p2align 6
L_loopA:
    v_mfma_f32_16x16x32_bf16 v[204:207], a[152:155], a[24:27], v[204:207]
    s_barrier
    v_mfma_f32_16x16x32_bf16 v[204:207], a[156:159], a[28:31], v[204:207]
    v_fma_f32 v200, v200, s32, v217
    v_fma_f32 v201, v201, s32, v217
    v_mfma_f32_16x16x32_bf16 v[0:3], a[192:195], v[192:195], v[0:3]
    v_exp_f32 v200, v200
    v_mfma_f32_16x16x32_bf16 v[4:7], a[196:199], v[192:195], v[4:7]
    v_exp_f32 v201, v201
    v_mfma_f32_16x16x32_bf16 v[8:11], a[200:203], v[192:195], v[8:11]
    v_fma_f32 v202, v202, s32, v217
    v_cvt_pk_bf16_f32 v200, v200, v201
    v_mfma_f32_16x16x32_bf16 v[12:15], a[204:207], v[192:195], v[12:15]
    v_exp_f32 v202, v202
    v_mfma_f32_16x16x32_bf16 v[16:19], a[208:211], v[192:195], v[16:19]
    ds_read_b128 a[96:99], v222 offset:0
    v_fma_f32 v203, v203, s32, v217
    v_mfma_f32_16x16x32_bf16 v[20:23], a[212:215], v[192:195], v[20:23]
    v_exp_f32 v203, v203
    v_mfma_f32_16x16x32_bf16 v[24:27], a[216:219], v[192:195], v[24:27]
    v_fma_f32 v204, v204, s32, v217
    v_cvt_pk_bf16_f32 v201, v202, v203
    v_mfma_f32_16x16x32_bf16 v[28:31], a[220:223], v[192:195], v[28:31]
    v_exp_f32 v204, v204
    v_mfma_f32_16x16x32_bf16 a[224:227], a[248:251], v[192:195], a[224:227]
    ds_read_b128 a[100:103], v222 offset:256
    v_fma_f32 v205, v205, s32, v217
    v_mfma_f32_16x16x32_bf16 v[192:195], a[128:131], a[32:35], 0
    v_exp_f32 v205, v205
    v_mfma_f32_16x16x32_bf16 v[192:195], a[132:135], a[36:39], v[192:195]
    v_fma_f32 v206, v206, s32, v217
    v_cvt_pk_bf16_f32 v202, v204, v205
    v_mfma_f32_16x16x32_bf16 v[192:195], a[136:139], a[40:43], v[192:195]
    v_exp_f32 v206, v206
    v_mfma_f32_16x16x32_bf16 v[192:195], a[140:143], a[44:47], v[192:195]
    ds_read_b128 a[104:107], v222 offset:512
    v_fma_f32 v207, v207, s32, v217
    v_mfma_f32_16x16x32_bf16 v[196:199], a[144:147], a[32:35], 0
    s_xor_b32 m0, s35, 0x8000
    v_exp_f32 v207, v207
    v_mfma_f32_16x16x32_bf16 v[196:199], a[148:151], a[36:39], v[196:199]
    ds_read_b128 a[108:111], v222 offset:768
    v_cvt_pk_bf16_f32 v203, v206, v207
    v_mfma_f32_16x16x32_bf16 v[196:199], a[152:155], a[40:43], v[196:199]
    buffer_load_dwordx4 v250, s[12:15], s34 offen nt lds
    v_mfma_f32_16x16x32_bf16 v[196:199], a[156:159], a[44:47], v[196:199]
    v_fma_f32 v192, v192, s32, v218
    v_fma_f32 v193, v193, s32, v218
    v_mfma_f32_16x16x32_bf16 v[32:35], a[192:195], v[200:203], v[32:35]
    v_exp_f32 v192, v192
    v_mfma_f32_16x16x32_bf16 v[36:39], a[196:199], v[200:203], v[36:39]
    v_exp_f32 v193, v193
    v_mfma_f32_16x16x32_bf16 v[40:43], a[200:203], v[200:203], v[40:43]
    v_fma_f32 v194, v194, s32, v218
    v_cvt_pk_bf16_f32 v192, v192, v193
    v_mfma_f32_16x16x32_bf16 v[44:47], a[204:207], v[200:203], v[44:47]
    v_exp_f32 v194, v194
    v_mfma_f32_16x16x32_bf16 v[48:51], a[208:211], v[200:203], v[48:51]
    ds_read_b128 a[112:115], v222 offset:1024
    v_fma_f32 v195, v195, s32, v218
    v_mfma_f32_16x16x32_bf16 v[52:55], a[212:215], v[200:203], v[52:55]
    v_exp_f32 v195, v195
    v_mfma_f32_16x16x32_bf16 v[56:59], a[216:219], v[200:203], v[56:59]
    v_fma_f32 v196, v196, s32, v218
    v_cvt_pk_bf16_f32 v193, v194, v195
    v_mfma_f32_16x16x32_bf16 v[60:63], a[220:223], v[200:203], v[60:63]
    v_exp_f32 v196, v196
    v_mfma_f32_16x16x32_bf16 a[228:231], a[248:251], v[200:203], a[228:231]
    ds_read_b128 a[116:119], v222 offset:1280
    v_fma_f32 v197, v197, s32, v218
    v_mfma_f32_16x16x32_bf16 v[200:203], a[128:131], a[48:51], 0
    v_exp_f32 v197, v197
    v_mfma_f32_16x16x32_bf16 v[200:203], a[132:135], a[52:55], v[200:203]
    v_fma_f32 v198, v198, s32, v218
    v_cvt_pk_bf16_f32 v194, v196, v197
    v_mfma_f32_16x16x32_bf16 v[200:203], a[136:139], a[56:59], v[200:203]
    v_exp_f32 v198, v198
    v_mfma_f32_16x16x32_bf16 v[200:203], a[140:143], a[60:63], v[200:203]
    ds_read_b128 a[120:123], v222 offset:1536
    v_fma_f32 v199, v199, s32, v218
    v_mfma_f32_16x16x32_bf16 v[204:207], a[144:147], a[48:51], 0
    v_exp_f32 v199, v199
    v_mfma_f32_16x16x32_bf16 v[204:207], a[148:151], a[52:55], v[204:207]
    ds_read_b128 a[124:127], v222 offset:1792
    v_cvt_pk_bf16_f32 v195, v198, v199
    v_mfma_f32_16x16x32_bf16 v[204:207], a[152:155], a[56:59], v[204:207]
    buffer_load_dwordx4 v250, s[12:15], s34 offen offset:1024 nt lds
    v_mfma_f32_16x16x32_bf16 v[204:207], a[156:159], a[60:63], v[204:207]
    v_fma_f32 v200, v200, s32, v219
    v_fma_f32 v201, v201, s32, v219
    v_mfma_f32_16x16x32_bf16 v[64:67], a[192:195], v[192:195], v[64:67]
    v_exp_f32 v200, v200
    v_mfma_f32_16x16x32_bf16 v[68:71], a[196:199], v[192:195], v[68:71]
    v_exp_f32 v201, v201
    v_mfma_f32_16x16x32_bf16 v[72:75], a[200:203], v[192:195], v[72:75]
    v_fma_f32 v202, v202, s32, v219
    v_cvt_pk_bf16_f32 v200, v200, v201
    v_mfma_f32_16x16x32_bf16 v[76:79], a[204:207], v[192:195], v[76:79]
    v_exp_f32 v202, v202
    v_mfma_f32_16x16x32_bf16 v[80:83], a[208:211], v[192:195], v[80:83]
    ds_read_b64_tr_b16 a[160:161], v223 offset:0
    v_fma_f32 v203, v203, s32, v219
    v_mfma_f32_16x16x32_bf16 v[84:87], a[212:215], v[192:195], v[84:87]
    v_exp_f32 v203, v203
    v_mfma_f32_16x16x32_bf16 v[88:91], a[216:219], v[192:195], v[88:91]
    v_fma_f32 v204, v204, s32, v219
    v_cvt_pk_bf16_f32 v201, v202, v203
    v_mfma_f32_16x16x32_bf16 v[92:95], a[220:223], v[192:195], v[92:95]
    v_exp_f32 v204, v204
    v_mfma_f32_16x16x32_bf16 a[232:235], a[248:251], v[192:195], a[232:235]
    ds_read_b64_tr_b16 a[162:163], v223 offset:1024
    v_fma_f32 v205, v205, s32, v219
    v_mfma_f32_16x16x32_bf16 v[192:195], a[128:131], a[64:67], 0
    v_exp_f32 v205, v205
    v_mfma_f32_16x16x32_bf16 v[192:195], a[132:135], a[68:71], v[192:195]
    v_fma_f32 v206, v206, s32, v219
    v_cvt_pk_bf16_f32 v202, v204, v205
    v_mfma_f32_16x16x32_bf16 v[192:195], a[136:139], a[72:75], v[192:195]
    v_exp_f32 v206, v206
    v_mfma_f32_16x16x32_bf16 v[192:195], a[140:143], a[76:79], v[192:195]
    ds_read_b64_tr_b16 a[164:165], v224 offset:0
    v_fma_f32 v207, v207, s32, v219
    v_mfma_f32_16x16x32_bf16 v[196:199], a[144:147], a[64:67], 0
    s_waitcnt lgkmcnt(3)
    v_exp_f32 v207, v207
    v_mfma_f32_16x16x32_bf16 v[196:199], a[148:151], a[68:71], v[196:199]
    s_mov_b32 m0, s35
    ds_read_b64_tr_b16 a[166:167], v224 offset:1024
    v_cvt_pk_bf16_f32 v203, v206, v207
    v_mfma_f32_16x16x32_bf16 v[196:199], a[152:155], a[72:75], v[196:199]
    buffer_load_dwordx4 v249, s[8:11], s34 offen nt lds
    v_mfma_f32_16x16x32_bf16 v[196:199], a[156:159], a[76:79], v[196:199]
    v_fma_f32 v192, v192, s32, v220
    v_fma_f32 v193, v193, s32, v220
    v_mfma_f32_16x16x32_bf16 v[96:99], a[192:195], v[200:203], v[96:99]
    v_exp_f32 v192, v192
    v_mfma_f32_16x16x32_bf16 v[100:103], a[196:199], v[200:203], v[100:103]
    v_exp_f32 v193, v193
    v_mfma_f32_16x16x32_bf16 v[104:107], a[200:203], v[200:203], v[104:107]
    v_fma_f32 v194, v194, s32, v220
    v_cvt_pk_bf16_f32 v192, v192, v193
    v_mfma_f32_16x16x32_bf16 v[108:111], a[204:207], v[200:203], v[108:111]
    v_exp_f32 v194, v194
    v_mfma_f32_16x16x32_bf16 v[112:115], a[208:211], v[200:203], v[112:115]
    ds_read_b64_tr_b16 a[168:169], v223 offset:256
    v_fma_f32 v195, v195, s32, v220
    v_mfma_f32_16x16x32_bf16 v[116:119], a[212:215], v[200:203], v[116:119]
    v_exp_f32 v195, v195
    v_mfma_f32_16x16x32_bf16 v[120:123], a[216:219], v[200:203], v[120:123]
    v_fma_f32 v196, v196, s32, v220
    v_cvt_pk_bf16_f32 v193, v194, v195
    v_mfma_f32_16x16x32_bf16 v[124:127], a[220:223], v[200:203], v[124:127]
    v_exp_f32 v196, v196
    v_mfma_f32_16x16x32_bf16 a[236:239], a[248:251], v[200:203], a[236:239]
    ds_read_b64_tr_b16 a[170:171], v223 offset:1280
    v_fma_f32 v197, v197, s32, v220
    v_mfma_f32_16x16x32_bf16 v[200:203], a[128:131], a[80:83], 0
    v_exp_f32 v197, v197
    v_mfma_f32_16x16x32_bf16 v[200:203], a[132:135], a[84:87], v[200:203]
    v_fma_f32 v198, v198, s32, v220
    v_cvt_pk_bf16_f32 v194, v196, v197
    v_mfma_f32_16x16x32_bf16 v[200:203], a[136:139], a[88:91], v[200:203]
    v_exp_f32 v198, v198
    v_mfma_f32_16x16x32_bf16 v[200:203], a[140:143], a[92:95], v[200:203]
    ds_read_b64_tr_b16 a[172:173], v224 offset:256
    v_fma_f32 v199, v199, s32, v220
    v_mfma_f32_16x16x32_bf16 v[204:207], a[144:147], a[80:83], 0
    v_exp_f32 v199, v199
    v_mfma_f32_16x16x32_bf16 v[204:207], a[148:151], a[84:87], v[204:207]
    ds_read_b64_tr_b16 a[174:175], v224 offset:1280
    v_cvt_pk_bf16_f32 v195, v198, v199
    v_mfma_f32_16x16x32_bf16 v[204:207], a[152:155], a[88:91], v[204:207]
    buffer_load_dwordx4 v249, s[8:11], s34 offen offset:1024 nt lds
    v_mfma_f32_16x16x32_bf16 v[204:207], a[156:159], a[92:95], v[204:207]
    ds_read_b64_tr_b16 a[176:177], v223 offset:512
    v_fma_f32 v200, v200, s32, v221
    v_mfma_f32_16x16x32_bf16 v[128:131], a[192:195], v[192:195], v[128:131]
    s_add_u32 s34, s34, 0x2000
    v_exp_f32 v200, v200
    v_mfma_f32_16x16x32_bf16 v[132:135], a[196:199], v[192:195], v[132:135]
    ds_read_b64_tr_b16 a[178:179], v223 offset:1536
    v_fma_f32 v201, v201, s32, v221
    v_mfma_f32_16x16x32_bf16 v[136:139], a[200:203], v[192:195], v[136:139]
    s_xor_b32 s35, s35, 0x6000
    v_exp_f32 v201, v201
    v_mfma_f32_16x16x32_bf16 v[140:143], a[204:207], v[192:195], v[140:143]
    v_fma_f32 v202, v202, s32, v221
    v_cvt_pk_bf16_f32 v200, v200, v201
    v_mfma_f32_16x16x32_bf16 v[144:147], a[208:211], v[192:195], v[144:147]
    v_exp_f32 v202, v202
    v_mfma_f32_16x16x32_bf16 v[148:151], a[212:215], v[192:195], v[148:151]
    ds_read_b64_tr_b16 a[180:181], v224 offset:512
    v_fma_f32 v203, v203, s32, v221
    v_mfma_f32_16x16x32_bf16 v[152:155], a[216:219], v[192:195], v[152:155]
    v_exp_f32 v203, v203
    v_mfma_f32_16x16x32_bf16 v[156:159], a[220:223], v[192:195], v[156:159]
    v_fma_f32 v204, v204, s32, v221
    v_cvt_pk_bf16_f32 v201, v202, v203
    v_mfma_f32_16x16x32_bf16 a[240:243], a[248:251], v[192:195], a[240:243]
    v_exp_f32 v204, v204
    v_mfma_f32_16x16x32_bf16 v[192:195], a[96:99], a[0:3], 0
    ds_read_b64_tr_b16 a[182:183], v224 offset:1536
    v_fma_f32 v205, v205, s32, v221
    v_mfma_f32_16x16x32_bf16 v[192:195], a[100:103], a[4:7], v[192:195]
    v_exp_f32 v205, v205
    v_mfma_f32_16x16x32_bf16 v[192:195], a[104:107], a[8:11], v[192:195]
    v_fma_f32 v206, v206, s32, v221
    v_cvt_pk_bf16_f32 v202, v204, v205
    v_mfma_f32_16x16x32_bf16 v[192:195], a[108:111], a[12:15], v[192:195]
    v_exp_f32 v206, v206
    v_mfma_f32_16x16x32_bf16 v[196:199], a[112:115], a[0:3], 0
    ds_read_b64_tr_b16 a[184:185], v223 offset:768
    v_fma_f32 v207, v207, s32, v221
    v_mfma_f32_16x16x32_bf16 v[196:199], a[116:119], a[4:7], v[196:199]
    v_exp_f32 v207, v207
    v_mfma_f32_16x16x32_bf16 v[196:199], a[120:123], a[8:11], v[196:199]
    ds_read_b64_tr_b16 a[186:187], v223 offset:1792
    v_cvt_pk_bf16_f32 v203, v206, v207
    v_mfma_f32_16x16x32_bf16 v[196:199], a[124:127], a[12:15], v[196:199]
    ds_read_b64_tr_b16 a[188:189], v224 offset:768
    v_fma_f32 v192, v192, s32, v216
    v_mfma_f32_16x16x32_bf16 v[160:163], a[192:195], v[200:203], v[160:163]
    v_exp_f32 v192, v192
    v_mfma_f32_16x16x32_bf16 v[164:167], a[196:199], v[200:203], v[164:167]
    ds_read_b64_tr_b16 a[190:191], v224 offset:1792
    v_fma_f32 v193, v193, s32, v216
    v_mfma_f32_16x16x32_bf16 v[168:171], a[200:203], v[200:203], v[168:171]
    v_exp_f32 v193, v193
    v_mfma_f32_16x16x32_bf16 v[172:175], a[204:207], v[200:203], v[172:175]
    v_fma_f32 v194, v194, s32, v216
    v_cvt_pk_bf16_f32 v192, v192, v193
    v_mfma_f32_16x16x32_bf16 v[176:179], a[208:211], v[200:203], v[176:179]
    v_exp_f32 v194, v194
    v_mfma_f32_16x16x32_bf16 v[180:183], a[212:215], v[200:203], v[180:183]
    v_fma_f32 v195, v195, s32, v216
    v_fma_f32 v196, v196, s32, v216
    v_mfma_f32_16x16x32_bf16 v[184:187], a[216:219], v[200:203], v[184:187]
    v_exp_f32 v195, v195
    v_mfma_f32_16x16x32_bf16 v[188:191], a[220:223], v[200:203], v[188:191]
    v_exp_f32 v196, v196
    v_mfma_f32_16x16x32_bf16 a[244:247], a[248:251], v[200:203], a[244:247]
    v_fma_f32 v197, v197, s32, v216
    v_cvt_pk_bf16_f32 v193, v194, v195
    v_mfma_f32_16x16x32_bf16 v[200:203], a[96:99], a[16:19], 0
    v_exp_f32 v197, v197
    v_mfma_f32_16x16x32_bf16 v[200:203], a[100:103], a[20:23], v[200:203]
    v_fma_f32 v198, v198, s32, v216
    v_fma_f32 v199, v199, s32, v216
    v_mfma_f32_16x16x32_bf16 v[200:203], a[104:107], a[24:27], v[200:203]
    v_exp_f32 v198, v198
    v_mfma_f32_16x16x32_bf16 v[200:203], a[108:111], a[28:31], v[200:203]
    v_exp_f32 v199, v199
    v_mfma_f32_16x16x32_bf16 v[204:207], a[112:115], a[16:19], 0
    v_cvt_pk_bf16_f32 v194, v196, v197
    v_cvt_pk_bf16_f32 v195, v198, v199
    v_mfma_f32_16x16x32_bf16 v[204:207], a[116:119], a[20:23], v[204:207]
    s_waitcnt vmcnt(8) lgkmcnt(0)
    v_mfma_f32_16x16x32_bf16 v[204:207], a[120:123], a[24:27], v[204:207]
    s_barrier
    v_mfma_f32_16x16x32_bf16 v[204:207], a[124:127], a[28:31], v[204:207]
    v_fma_f32 v200, v200, s32, v217
    v_fma_f32 v201, v201, s32, v217
    v_mfma_f32_16x16x32_bf16 v[0:3], a[160:163], v[192:195], v[0:3]
    v_exp_f32 v200, v200
    v_mfma_f32_16x16x32_bf16 v[4:7], a[164:167], v[192:195], v[4:7]
    v_exp_f32 v201, v201
    v_mfma_f32_16x16x32_bf16 v[8:11], a[168:171], v[192:195], v[8:11]
    v_fma_f32 v202, v202, s32, v217
    v_cvt_pk_bf16_f32 v200, v200, v201
    v_mfma_f32_16x16x32_bf16 v[12:15], a[172:175], v[192:195], v[12:15]
    v_exp_f32 v202, v202
    v_mfma_f32_16x16x32_bf16 v[16:19], a[176:179], v[192:195], v[16:19]
    ds_read_b128 a[128:131], v222 offset:8192
    v_fma_f32 v203, v203, s32, v217
    v_mfma_f32_16x16x32_bf16 v[20:23], a[180:183], v[192:195], v[20:23]
    v_exp_f32 v203, v203
    v_mfma_f32_16x16x32_bf16 v[24:27], a[184:187], v[192:195], v[24:27]
    v_fma_f32 v204, v204, s32, v217
    v_cvt_pk_bf16_f32 v201, v202, v203
    v_mfma_f32_16x16x32_bf16 v[28:31], a[188:191], v[192:195], v[28:31]
    v_exp_f32 v204, v204
    v_mfma_f32_16x16x32_bf16 a[224:227], a[248:251], v[192:195], a[224:227]
    ds_read_b128 a[132:135], v222 offset:8448
    v_fma_f32 v205, v205, s32, v217
    v_mfma_f32_16x16x32_bf16 v[192:195], a[96:99], a[32:35], 0
    v_exp_f32 v205, v205
    v_mfma_f32_16x16x32_bf16 v[192:195], a[100:103], a[36:39], v[192:195]
    v_fma_f32 v206, v206, s32, v217
    v_cvt_pk_bf16_f32 v202, v204, v205
    v_mfma_f32_16x16x32_bf16 v[192:195], a[104:107], a[40:43], v[192:195]
    v_exp_f32 v206, v206
    v_mfma_f32_16x16x32_bf16 v[192:195], a[108:111], a[44:47], v[192:195]
    ds_read_b128 a[136:139], v222 offset:8704
    v_fma_f32 v207, v207, s32, v217
    v_mfma_f32_16x16x32_bf16 v[196:199], a[112:115], a[32:35], 0
    s_xor_b32 m0, s35, 0x8000
    v_exp_f32 v207, v207
    v_mfma_f32_16x16x32_bf16 v[196:199], a[116:119], a[36:39], v[196:199]
    ds_read_b128 a[140:143], v222 offset:8960
    v_cvt_pk_bf16_f32 v203, v206, v207
    v_mfma_f32_16x16x32_bf16 v[196:199], a[120:123], a[40:43], v[196:199]
    buffer_load_dwordx4 v250, s[12:15], s34 offen nt lds
    v_mfma_f32_16x16x32_bf16 v[196:199], a[124:127], a[44:47], v[196:199]
    v_fma_f32 v192, v192, s32, v218
    v_fma_f32 v193, v193, s32, v218
    v_mfma_f32_16x16x32_bf16 v[32:35], a[160:163], v[200:203], v[32:35]
    v_exp_f32 v192, v192
    v_mfma_f32_16x16x32_bf16 v[36:39], a[164:167], v[200:203], v[36:39]
    v_exp_f32 v193, v193
    v_mfma_f32_16x16x32_bf16 v[40:43], a[168:171], v[200:203], v[40:43]
    v_fma_f32 v194, v194, s32, v218
    v_cvt_pk_bf16_f32 v192, v192, v193
    v_mfma_f32_16x16x32_bf16 v[44:47], a[172:175], v[200:203], v[44:47]
    v_exp_f32 v194, v194
    v_mfma_f32_16x16x32_bf16 v[48:51], a[176:179], v[200:203], v[48:51]
    ds_read_b128 a[144:147], v222 offset:9216
    v_fma_f32 v195, v195, s32, v218
    v_mfma_f32_16x16x32_bf16 v[52:55], a[180:183], v[200:203], v[52:55]
    v_exp_f32 v195, v195
    v_mfma_f32_16x16x32_bf16 v[56:59], a[184:187], v[200:203], v[56:59]
    v_fma_f32 v196, v196, s32, v218
    v_cvt_pk_bf16_f32 v193, v194, v195
    v_mfma_f32_16x16x32_bf16 v[60:63], a[188:191], v[200:203], v[60:63]
    v_exp_f32 v196, v196
    v_mfma_f32_16x16x32_bf16 a[228:231], a[248:251], v[200:203], a[228:231]
    ds_read_b128 a[148:151], v222 offset:9472
    v_fma_f32 v197, v197, s32, v218
    v_mfma_f32_16x16x32_bf16 v[200:203], a[96:99], a[48:51], 0
    v_exp_f32 v197, v197
    v_mfma_f32_16x16x32_bf16 v[200:203], a[100:103], a[52:55], v[200:203]
    v_fma_f32 v198, v198, s32, v218
    v_cvt_pk_bf16_f32 v194, v196, v197
    v_mfma_f32_16x16x32_bf16 v[200:203], a[104:107], a[56:59], v[200:203]
    v_exp_f32 v198, v198
    v_mfma_f32_16x16x32_bf16 v[200:203], a[108:111], a[60:63], v[200:203]
    ds_read_b128 a[152:155], v222 offset:9728
    v_fma_f32 v199, v199, s32, v218
    v_mfma_f32_16x16x32_bf16 v[204:207], a[112:115], a[48:51], 0
    v_exp_f32 v199, v199
    v_mfma_f32_16x16x32_bf16 v[204:207], a[116:119], a[52:55], v[204:207]
    ds_read_b128 a[156:159], v222 offset:9984
    v_cvt_pk_bf16_f32 v195, v198, v199
    v_mfma_f32_16x16x32_bf16 v[204:207], a[120:123], a[56:59], v[204:207]
    buffer_load_dwordx4 v250, s[12:15], s34 offen offset:1024 nt lds
    v_mfma_f32_16x16x32_bf16 v[204:207], a[124:127], a[60:63], v[204:207]
    v_fma_f32 v200, v200, s32, v219
    v_fma_f32 v201, v201, s32, v219
    v_mfma_f32_16x16x32_bf16 v[64:67], a[160:163], v[192:195], v[64:67]
    v_exp_f32 v200, v200
    v_mfma_f32_16x16x32_bf16 v[68:71], a[164:167], v[192:195], v[68:71]
    v_exp_f32 v201, v201
    v_xor_b32 v222, 0x4000, v222
    v_mfma_f32_16x16x32_bf16 v[72:75], a[168:171], v[192:195], v[72:75]
    v_fma_f32 v202, v202, s32, v219
    v_cvt_pk_bf16_f32 v200, v200, v201
    v_mfma_f32_16x16x32_bf16 v[76:79], a[172:175], v[192:195], v[76:79]
    v_exp_f32 v202, v202
    v_mfma_f32_16x16x32_bf16 v[80:83], a[176:179], v[192:195], v[80:83]
    ds_read_b64_tr_b16 a[192:193], v223 offset:8192
    v_fma_f32 v203, v203, s32, v219
    v_mfma_f32_16x16x32_bf16 v[84:87], a[180:183], v[192:195], v[84:87]
    v_exp_f32 v203, v203
    v_mfma_f32_16x16x32_bf16 v[88:91], a[184:187], v[192:195], v[88:91]
    v_fma_f32 v204, v204, s32, v219
    v_cvt_pk_bf16_f32 v201, v202, v203
    v_mfma_f32_16x16x32_bf16 v[92:95], a[188:191], v[192:195], v[92:95]
    v_exp_f32 v204, v204
    v_mfma_f32_16x16x32_bf16 a[232:235], a[248:251], v[192:195], a[232:235]
    ds_read_b64_tr_b16 a[194:195], v223 offset:9216
    v_fma_f32 v205, v205, s32, v219
    v_mfma_f32_16x16x32_bf16 v[192:195], a[96:99], a[64:67], 0
    v_exp_f32 v205, v205
    v_mfma_f32_16x16x32_bf16 v[192:195], a[100:103], a[68:71], v[192:195]
    v_fma_f32 v206, v206, s32, v219
    v_cvt_pk_bf16_f32 v202, v204, v205
    v_mfma_f32_16x16x32_bf16 v[192:195], a[104:107], a[72:75], v[192:195]
    v_exp_f32 v206, v206
    v_mfma_f32_16x16x32_bf16 v[192:195], a[108:111], a[76:79], v[192:195]
    ds_read_b64_tr_b16 a[196:197], v224 offset:8192
    v_fma_f32 v207, v207, s32, v219
    v_mfma_f32_16x16x32_bf16 v[196:199], a[112:115], a[64:67], 0
    s_waitcnt lgkmcnt(3)
    v_exp_f32 v207, v207
    v_mfma_f32_16x16x32_bf16 v[196:199], a[116:119], a[68:71], v[196:199]
    s_mov_b32 m0, s35
    ds_read_b64_tr_b16 a[198:199], v224 offset:9216
    v_cvt_pk_bf16_f32 v203, v206, v207
    v_mfma_f32_16x16x32_bf16 v[196:199], a[120:123], a[72:75], v[196:199]
    buffer_load_dwordx4 v249, s[8:11], s34 offen nt lds
    v_mfma_f32_16x16x32_bf16 v[196:199], a[124:127], a[76:79], v[196:199]
    v_fma_f32 v192, v192, s32, v220
    v_fma_f32 v193, v193, s32, v220
    v_mfma_f32_16x16x32_bf16 v[96:99], a[160:163], v[200:203], v[96:99]
    v_exp_f32 v192, v192
    v_mfma_f32_16x16x32_bf16 v[100:103], a[164:167], v[200:203], v[100:103]
    v_exp_f32 v193, v193
    v_mfma_f32_16x16x32_bf16 v[104:107], a[168:171], v[200:203], v[104:107]
    v_fma_f32 v194, v194, s32, v220
    v_cvt_pk_bf16_f32 v192, v192, v193
    v_mfma_f32_16x16x32_bf16 v[108:111], a[172:175], v[200:203], v[108:111]
    v_exp_f32 v194, v194
    v_mfma_f32_16x16x32_bf16 v[112:115], a[176:179], v[200:203], v[112:115]
    ds_read_b64_tr_b16 a[200:201], v223 offset:8448
    v_fma_f32 v195, v195, s32, v220
    v_mfma_f32_16x16x32_bf16 v[116:119], a[180:183], v[200:203], v[116:119]
    v_exp_f32 v195, v195
    v_mfma_f32_16x16x32_bf16 v[120:123], a[184:187], v[200:203], v[120:123]
    v_fma_f32 v196, v196, s32, v220
    v_cvt_pk_bf16_f32 v193, v194, v195
    v_mfma_f32_16x16x32_bf16 v[124:127], a[188:191], v[200:203], v[124:127]
    v_exp_f32 v196, v196
    v_mfma_f32_16x16x32_bf16 a[236:239], a[248:251], v[200:203], a[236:239]
    ds_read_b64_tr_b16 a[202:203], v223 offset:9472
    v_fma_f32 v197, v197, s32, v220
    v_mfma_f32_16x16x32_bf16 v[200:203], a[96:99], a[80:83], 0
    v_exp_f32 v197, v197
    v_mfma_f32_16x16x32_bf16 v[200:203], a[100:103], a[84:87], v[200:203]
    v_fma_f32 v198, v198, s32, v220
    v_cvt_pk_bf16_f32 v194, v196, v197
    v_mfma_f32_16x16x32_bf16 v[200:203], a[104:107], a[88:91], v[200:203]
    v_exp_f32 v198, v198
    v_mfma_f32_16x16x32_bf16 v[200:203], a[108:111], a[92:95], v[200:203]
    ds_read_b64_tr_b16 a[204:205], v224 offset:8448
    v_fma_f32 v199, v199, s32, v220
    v_mfma_f32_16x16x32_bf16 v[204:207], a[112:115], a[80:83], 0
    v_exp_f32 v199, v199
    v_mfma_f32_16x16x32_bf16 v[204:207], a[116:119], a[84:87], v[204:207]
    ds_read_b64_tr_b16 a[206:207], v224 offset:9472
    v_cvt_pk_bf16_f32 v195, v198, v199
    v_mfma_f32_16x16x32_bf16 v[204:207], a[120:123], a[88:91], v[204:207]
    buffer_load_dwordx4 v249, s[8:11], s34 offen offset:1024 nt lds
    v_mfma_f32_16x16x32_bf16 v[204:207], a[124:127], a[92:95], v[204:207]
    ds_read_b64_tr_b16 a[208:209], v223 offset:8704
    v_fma_f32 v200, v200, s32, v221
    v_mfma_f32_16x16x32_bf16 v[128:131], a[160:163], v[192:195], v[128:131]
    s_add_u32 s34, s34, 0x2000
    v_exp_f32 v200, v200
    v_mfma_f32_16x16x32_bf16 v[132:135], a[164:167], v[192:195], v[132:135]
    s_mov_b32 m0, s36
    ds_read_b64_tr_b16 a[210:211], v223 offset:9728
    v_fma_f32 v201, v201, s32, v221
    v_mfma_f32_16x16x32_bf16 v[136:139], a[168:171], v[192:195], v[136:139]
    s_xor_b32 s35, s35, 0x2000
    v_exp_f32 v201, v201
    v_mfma_f32_16x16x32_bf16 v[140:143], a[172:175], v[192:195], v[140:143]
    v_fma_f32 v202, v202, s32, v221
    v_cvt_pk_bf16_f32 v200, v200, v201
    v_mfma_f32_16x16x32_bf16 v[144:147], a[176:179], v[192:195], v[144:147]
    buffer_load_dwordx4 v251, s[16:19], s37 offen nt lds
    v_exp_f32 v202, v202
    v_mfma_f32_16x16x32_bf16 v[148:151], a[180:183], v[192:195], v[148:151]
    ds_read_b64_tr_b16 a[212:213], v224 offset:8704
    v_fma_f32 v203, v203, s32, v221
    v_mfma_f32_16x16x32_bf16 v[152:155], a[184:187], v[192:195], v[152:155]
    buffer_load_dwordx4 v251, s[16:19], s37 offen offset:1024 nt lds
    v_exp_f32 v203, v203
    v_mfma_f32_16x16x32_bf16 v[156:159], a[188:191], v[192:195], v[156:159]
    v_fma_f32 v204, v204, s32, v221
    v_cvt_pk_bf16_f32 v201, v202, v203
    v_mfma_f32_16x16x32_bf16 a[240:243], a[248:251], v[192:195], a[240:243]
    s_add_u32 s36, s36, 0x800
    v_exp_f32 v204, v204
    v_xor_b32 v251, 32, v251
    v_mfma_f32_16x16x32_bf16 v[192:195], a[128:131], a[0:3], 0
    ds_read_b64_tr_b16 a[214:215], v224 offset:9728
    v_fma_f32 v205, v205, s32, v221
    v_mfma_f32_16x16x32_bf16 v[192:195], a[132:135], a[4:7], v[192:195]
    s_add_u32 s37, s37, 0x800
    v_exp_f32 v205, v205
    v_mfma_f32_16x16x32_bf16 v[192:195], a[136:139], a[8:11], v[192:195]
    v_fma_f32 v206, v206, s32, v221
    v_cvt_pk_bf16_f32 v202, v204, v205
    v_mfma_f32_16x16x32_bf16 v[192:195], a[140:143], a[12:15], v[192:195]
    v_exp_f32 v206, v206
    v_mfma_f32_16x16x32_bf16 v[196:199], a[144:147], a[0:3], 0
    ds_read_b64_tr_b16 a[216:217], v223 offset:8960
    v_fma_f32 v207, v207, s32, v221
    v_mfma_f32_16x16x32_bf16 v[196:199], a[148:151], a[4:7], v[196:199]
    v_exp_f32 v207, v207
    v_mfma_f32_16x16x32_bf16 v[196:199], a[152:155], a[8:11], v[196:199]
    ds_read_b64_tr_b16 a[218:219], v223 offset:9984
    v_cvt_pk_bf16_f32 v203, v206, v207
    v_mfma_f32_16x16x32_bf16 v[196:199], a[156:159], a[12:15], v[196:199]
    ds_read_b64_tr_b16 a[220:221], v224 offset:8960
    v_fma_f32 v192, v192, s32, v216
    v_mfma_f32_16x16x32_bf16 v[160:163], a[160:163], v[200:203], v[160:163]
    v_exp_f32 v192, v192
    v_mfma_f32_16x16x32_bf16 v[164:167], a[164:167], v[200:203], v[164:167]
    ds_read_b64_tr_b16 a[222:223], v224 offset:9984
    v_fma_f32 v193, v193, s32, v216
    v_mfma_f32_16x16x32_bf16 v[168:171], a[168:171], v[200:203], v[168:171]
    v_exp_f32 v193, v193
    v_mfma_f32_16x16x32_bf16 v[172:175], a[172:175], v[200:203], v[172:175]
    v_fma_f32 v194, v194, s32, v216
    v_cvt_pk_bf16_f32 v192, v192, v193
    v_xor_b32 v223, 0x4000, v223
    v_mfma_f32_16x16x32_bf16 v[176:179], a[176:179], v[200:203], v[176:179]
    v_exp_f32 v194, v194
    v_mfma_f32_16x16x32_bf16 v[180:183], a[180:183], v[200:203], v[180:183]
    v_fma_f32 v195, v195, s32, v216
    v_fma_f32 v196, v196, s32, v216
    v_xor_b32 v224, 0x4000, v224
    v_mfma_f32_16x16x32_bf16 v[184:187], a[184:187], v[200:203], v[184:187]
    v_exp_f32 v195, v195
    v_mfma_f32_16x16x32_bf16 v[188:191], a[188:191], v[200:203], v[188:191]
    v_exp_f32 v196, v196
    v_mfma_f32_16x16x32_bf16 a[244:247], a[248:251], v[200:203], a[244:247]
    v_fma_f32 v197, v197, s32, v216
    v_cvt_pk_bf16_f32 v193, v194, v195
    v_mfma_f32_16x16x32_bf16 v[200:203], a[128:131], a[16:19], 0
    v_exp_f32 v197, v197
    v_mfma_f32_16x16x32_bf16 v[200:203], a[132:135], a[20:23], v[200:203]
    v_fma_f32 v198, v198, s32, v216
    v_fma_f32 v199, v199, s32, v216
    v_mfma_f32_16x16x32_bf16 v[200:203], a[136:139], a[24:27], v[200:203]
    s_sub_u32 s38, s38, 1
    v_exp_f32 v198, v198
    v_mfma_f32_16x16x32_bf16 v[200:203], a[140:143], a[28:31], v[200:203]
    s_cmp_lg_u32 s38, 0
    v_exp_f32 v199, v199
    v_mfma_f32_16x16x32_bf16 v[204:207], a[144:147], a[16:19], 0
    v_cvt_pk_bf16_f32 v194, v196, v197
    v_cvt_pk_bf16_f32 v195, v198, v199
    v_mfma_f32_16x16x32_bf16 v[204:207], a[148:151], a[20:23], v[204:207]
    s_waitcnt vmcnt(10) lgkmcnt(0)
    s_cbranch_scc1 L_loopA
    v_mfma_f32_16x16x32_bf16 v[204:207], a[152:155], a[24:27], v[204:207]
    s_barrier
    v_mfma_f32_16x16x32_bf16 v[204:207], a[156:159], a[28:31], v[204:207]
    s_mov_b32 m0, s36
    v_fma_f32 v200, v200, s32, v217
    v_fma_f32 v201, v201, s32, v217
    v_mfma_f32_16x16x32_bf16 v[0:3], a[192:195], v[192:195], v[0:3]
    buffer_load_dwordx4 v251, s[16:19], s37 offen nt lds
    v_mfma_f32_16x16x32_bf16 v[4:7], a[196:199], v[192:195], v[4:7]
    s_waitcnt vmcnt(41)
    ds_read_b128 a[0:3], v248 offset:0
    v_fma_f32 v202, v202, s32, v217
    v_mfma_f32_16x16x32_bf16 v[8:11], a[200:203], v[192:195], v[8:11]
    s_waitcnt vmcnt(21)
    ds_read_b128 a[4:7], v248 offset:256
    v_mfma_f32_16x16x32_bf16 v[12:15], a[204:207], v[192:195], v[12:15]
    s_mov_b32 s38, 6
    ds_read_b128 a[8:11], v248 offset:512
    v_fma_f32 v203, v203, s32, v217
    v_mfma_f32_16x16x32_bf16 v[16:19], a[208:211], v[192:195], v[16:19]
    ds_read_b128 a[12:15], v248 offset:768
    v_mfma_f32_16x16x32_bf16 v[20:23], a[212:215], v[192:195], v[20:23]
    v_exp_f32 v200, v200
    v_mfma_f32_16x16x32_bf16 v[24:27], a[216:219], v[192:195], v[24:27]
    ds_read_b128 a[16:19], v248 offset:4096
    v_fma_f32 v204, v204, s32, v217
    v_mfma_f32_16x16x32_bf16 v[28:31], a[220:223], v[192:195], v[28:31]
    buffer_load_dwordx4 v251, s[16:19], s37 offen offset:1024 nt lds
    v_mfma_f32_16x16x32_bf16 a[224:227], a[248:251], v[192:195], a[224:227]
    s_add_u32 s36, s36, 0x800
    ds_read_b128 a[20:23], v248 offset:4352
    s_add_u32 s37, s37, 0x800
    v_xor_b32 v251, 32, v251
    v_mfma_f32_16x16x32_bf16 v[192:195], a[128:131], a[32:35], 0
    ds_read_b128 a[24:27], v248 offset:4608
    v_exp_f32 v201, v201
    v_fma_f32 v205, v205, s32, v217
    v_mfma_f32_16x16x32_bf16 v[192:195], a[132:135], a[36:39], v[192:195]
    ds_read_b128 a[28:31], v248 offset:4864
    v_cvt_pk_bf16_f32 v200, v200, v201
    v_exp_f32 v202, v202
    v_mfma_f32_16x16x32_bf16 v[192:195], a[136:139], a[40:43], v[192:195]
    ds_read_b128 a[96:99], v222 offset:0
    v_exp_f32 v203, v203
    v_fma_f32 v206, v206, s32, v217
    v_mfma_f32_16x16x32_bf16 v[192:195], a[140:143], a[44:47], v[192:195]
    ds_read_b128 a[100:103], v222 offset:256
    v_cvt_pk_bf16_f32 v201, v202, v203
    v_exp_f32 v204, v204
    v_mfma_f32_16x16x32_bf16 v[196:199], a[144:147], a[32:35], 0
    s_mov_b32 m0, s36
    ds_read_b128 a[104:107], v222 offset:512
    v_exp_f32 v205, v205
    v_fma_f32 v207, v207, s32, v217
    v_mfma_f32_16x16x32_bf16 v[196:199], a[148:151], a[36:39], v[196:199]
    buffer_load_dwordx4 v251, s[16:19], s37 offen nt lds
    v_exp_f32 v206, v206
    v_exp_f32 v207, v207
    v_mfma_f32_16x16x32_bf16 v[196:199], a[152:155], a[40:43], v[196:199]
    v_cvt_pk_bf16_f32 v202, v204, v205
    v_cvt_pk_bf16_f32 v203, v206, v207
    v_mfma_f32_16x16x32_bf16 v[196:199], a[156:159], a[44:47], v[196:199]
    ds_read_b128 a[108:111], v222 offset:768
    v_fma_f32 v192, v192, s32, v218
    v_mfma_f32_16x16x32_bf16 v[32:35], a[192:195], v[200:203], v[32:35]
    v_exp_f32 v192, v192
    v_mfma_f32_16x16x32_bf16 v[36:39], a[196:199], v[200:203], v[36:39]
    ds_read_b128 a[112:115], v222 offset:1024
    v_fma_f32 v193, v193, s32, v218
    v_mfma_f32_16x16x32_bf16 v[40:43], a[200:203], v[200:203], v[40:43]
    v_exp_f32 v193, v193
    v_mfma_f32_16x16x32_bf16 v[44:47], a[204:207], v[200:203], v[44:47]
    v_cvt_pk_bf16_f32 v192, v192, v193
    v_fma_f32 v194, v194, s32, v218
    v_mfma_f32_16x16x32_bf16 v[48:51], a[208:211], v[200:203], v[48:51]
    buffer_load_dwordx4 v251, s[16:19], s37 offen offset:1024 nt lds
    v_mfma_f32_16x16x32_bf16 v[52:55], a[212:215], v[200:203], v[52:55]
    s_add_u32 s36, s36, 0x800
    s_add_u32 s37, s37, 0x800
    v_xor_b32 v251, 32, v251
    v_fma_f32 v195, v195, s32, v218
    v_mfma_f32_16x16x32_bf16 v[56:59], a[216:219], v[200:203], v[56:59]
    ds_read_b128 a[116:119], v222 offset:1280
    v_exp_f32 v194, v194
    v_mfma_f32_16x16x32_bf16 v[60:63], a[220:223], v[200:203], v[60:63]
    v_exp_f32 v195, v195
    v_fma_f32 v196, v196, s32, v218
    v_mfma_f32_16x16x32_bf16 a[228:231], a[248:251], v[200:203], a[228:231]
    v_cvt_pk_bf16_f32 v193, v194, v195
    v_exp_f32 v196, v196
    v_mfma_f32_16x16x32_bf16 v[200:203], a[128:131], a[48:51], 0
    v_fma_f32 v197, v197, s32, v218
    v_exp_f32 v197, v197
    v_mfma_f32_16x16x32_bf16 v[200:203], a[132:135], a[52:55], v[200:203]
    s_mov_b32 m0, s36
    ds_read_b128 a[120:123], v222 offset:1536
    v_cvt_pk_bf16_f32 v194, v196, v197
    v_fma_f32 v198, v198, s32, v218
    v_mfma_f32_16x16x32_bf16 v[200:203], a[136:139], a[56:59], v[200:203]
    buffer_load_dwordx4 v251, s[16:19], s37 offen nt lds
    v_mfma_f32_16x16x32_bf16 v[200:203], a[140:143], a[60:63], v[200:203]
    v_exp_f32 v198, v198
    v_fma_f32 v199, v199, s32, v218
    v_mfma_f32_16x16x32_bf16 v[204:207], a[144:147], a[48:51], 0
    ds_read_b128 a[124:127], v222 offset:1792
    ds_read_b64_tr_b16 a[160:161], v223 offset:0
    v_exp_f32 v199, v199
    v_mfma_f32_16x16x32_bf16 v[204:207], a[148:151], a[52:55], v[204:207]
    ds_read_b64_tr_b16 a[162:163], v223 offset:1024
    ds_read_b64_tr_b16 a[164:165], v224 offset:0
    v_cvt_pk_bf16_f32 v195, v198, v199
    v_accvgpr_read_b32 v254, a224
    v_mfma_f32_16x16x32_bf16 v[204:207], a[152:155], a[56:59], v[204:207]
    ds_read_b64_tr_b16 a[166:167], v224 offset:1024
    v_rcp_f32 v246, v254
    v_cmp_nge_f32 vcc, 0x4e800000, v254
    v_mfma_f32_16x16x32_bf16 v[204:207], a[156:159], a[60:63], v[204:207]
    v_fma_f32 v200, v200, s32, v219
    v_exp_f32 v200, v200
    v_fma_f32 v201, v201, s32, v219
    v_mfma_f32_16x16x32_bf16 v[64:67], a[192:195], v[192:195], v[64:67]
    s_or_b64 s[50:51], s[50:51], vcc
    v_exp_f32 v201, v201
    v_mul_f32 v0, v246, v0
    v_mul_f32 v1, v246, v1
    v_mfma_f32_16x16x32_bf16 v[68:71], a[196:199], v[192:195], v[68:71]
    buffer_load_dwordx4 v251, s[16:19], s37 offen offset:1024 nt lds
    v_mfma_f32_16x16x32_bf16 v[72:75], a[200:203], v[192:195], v[72:75]
    s_add_u32 s36, s36, 0x800
    s_add_u32 s37, s37, 0x800
    v_xor_b32 v251, 32, v251
    v_cvt_pk_bf16_f32 v200, v200, v201
    v_fma_f32 v202, v202, s32, v219
    v_mfma_f32_16x16x32_bf16 v[76:79], a[204:207], v[192:195], v[76:79]
    v_exp_f32 v202, v202
    v_fma_f32 v203, v203, s32, v219
    v_cvt_pk_bf16_f32 v0, v0, v1
    v_mfma_f32_16x16x32_bf16 v[80:83], a[208:211], v[192:195], v[80:83]
    v_exp_f32 v203, v203
    v_mul_f32 v2, v246, v2
    v_mul_f32 v3, v246, v3
    v_mfma_f32_16x16x32_bf16 v[84:87], a[212:215], v[192:195], v[84:87]
    v_cvt_pk_bf16_f32 v201, v202, v203
    v_fma_f32 v204, v204, s32, v219
    v_exp_f32 v204, v204
    v_mfma_f32_16x16x32_bf16 v[88:91], a[216:219], v[192:195], v[88:91]
    v_cvt_pk_bf16_f32 v1, v2, v3
    v_mul_f32 v8, v246, v8
    v_mul_f32 v9, v246, v9
    v_cvt_pk_bf16_f32 v8, v8, v9
    v_mfma_f32_16x16x32_bf16 v[92:95], a[220:223], v[192:195], v[92:95]
    s_mov_b32 m0, s36
    v_fma_f32 v205, v205, s32, v219
    v_mul_f32 v10, v246, v10
    v_mul_f32 v11, v246, v11
    v_cvt_pk_bf16_f32 v9, v10, v11
    v_mfma_f32_16x16x32_bf16 a[232:235], a[248:251], v[192:195], a[232:235]
    buffer_load_dwordx4 v251, s[16:19], s37 offen nt lds
    ds_write2_b64 v225, v[0:1], v[8:9] offset0:0 offset1:32
    v_mfma_f32_16x16x32_bf16 v[192:195], a[128:131], a[64:67], 0
    v_exp_f32 v205, v205
    v_fma_f32 v206, v206, s32, v219
    v_mul_f32 v4, v246, v4
    v_mfma_f32_16x16x32_bf16 v[192:195], a[132:135], a[68:71], v[192:195]
    v_cvt_pk_bf16_f32 v202, v204, v205
    v_exp_f32 v206, v206
    v_mul_f32 v5, v246, v5
    v_mfma_f32_16x16x32_bf16 v[192:195], a[136:139], a[72:75], v[192:195]
    v_fma_f32 v207, v207, s32, v219
    v_cvt_pk_bf16_f32 v4, v4, v5
    v_mul_f32 v6, v246, v6
    v_mul_f32 v7, v246, v7
    v_cvt_pk_bf16_f32 v5, v6, v7
    v_mfma_f32_16x16x32_bf16 v[192:195], a[140:143], a[76:79], v[192:195]
    v_mul_f32 v12, v246, v12
    v_mul_f32 v13, v246, v13
    v_cvt_pk_bf16_f32 v12, v12, v13
    v_mul_f32 v14, v246, v14
    v_mul_f32 v15, v246, v15
    v_mfma_f32_16x16x32_bf16 v[196:199], a[144:147], a[64:67], 0
    ds_read_b64_tr_b16 a[168:169], v223 offset:256
    v_cvt_pk_bf16_f32 v13, v14, v15
    v_exp_f32 v207, v207
    v_mul_f32 v16, v246, v16
    v_mfma_f32_16x16x32_bf16 v[196:199], a[148:151], a[68:71], v[196:199]
    ds_write2_b64 v226, v[4:5], v[12:13] offset0:0 offset1:32
    v_mfma_f32_16x16x32_bf16 v[196:199], a[152:155], a[72:75], v[196:199]
    buffer_load_dwordx4 v251, s[16:19], s37 offen offset:1024 nt lds
    v_cvt_pk_bf16_f32 v203, v206, v207
    v_mfma_f32_16x16x32_bf16 v[196:199], a[156:159], a[76:79], v[196:199]
    s_add_u32 s36, s36, 0x800
    s_add_u32 s37, s37, 0x800
    v_xor_b32 v251, 32, v251
    v_fma_f32 v192, v192, s32, v220
    v_mul_f32 v17, v246, v17
    v_mfma_f32_16x16x32_bf16 v[96:99], a[192:195], v[200:203], v[96:99]
    v_exp_f32 v192, v192
    v_cvt_pk_bf16_f32 v16, v16, v17
    v_mul_f32 v18, v246, v18
    v_mfma_f32_16x16x32_bf16 v[100:103], a[196:199], v[200:203], v[100:103]
    v_mul_f32 v19, v246, v19
    v_cvt_pk_bf16_f32 v17, v18, v19
    v_mul_f32 v24, v246, v24
    v_mul_f32 v25, v246, v25
    v_mfma_f32_16x16x32_bf16 v[104:107], a[200:203], v[200:203], v[104:107]
    v_cvt_pk_bf16_f32 v24, v24, v25
    v_mul_f32 v26, v246, v26
    v_mul_f32 v27, v246, v27
    v_cvt_pk_bf16_f32 v25, v26, v27
    v_fma_f32 v193, v193, s32, v220
    v_mfma_f32_16x16x32_bf16 v[108:111], a[204:207], v[200:203], v[108:111]
    ds_write2_b64 v225, v[16:17], v[24:25] offset0:64 offset1:96
    v_mfma_f32_16x16x32_bf16 v[112:115], a[208:211], v[200:203], v[112:115]
    s_mov_b32 m0, s36
    ds_read_b64_tr_b16 a[170:171], v223 offset:1280
    ds_read_b64_tr_b16 a[172:173], v224 offset:256
    v_exp_f32 v193, v193
    v_fma_f32 v194, v194, s32, v220
    v_mfma_f32_16x16x32_bf16 v[116:119], a[212:215], v[200:203], v[116:119]
    buffer_load_dwordx4 v251, s[16:19], s37 offen nt lds
    v_cvt_pk_bf16_f32 v192, v192, v193
    v_mul_f32 v20, v246, v20
    v_mfma_f32_16x16x32_bf16 v[120:123], a[216:219], v[200:203], v[120:123]
    v_exp_f32 v194, v194
    v_mul_f32 v21, v246, v21
    v_cvt_pk_bf16_f32 v20, v20, v21
    v_mul_f32 v22, v246, v22
    v_mul_f32 v23, v246, v23
    v_mfma_f32_16x16x32_bf16 v[124:127], a[220:223], v[200:203], v[124:127]
    v_cvt_pk_bf16_f32 v21, v22, v23
    v_mul_f32 v28, v246, v28
    v_mul_f32 v29, v246, v29
    v_cvt_pk_bf16_f32 v28, v28, v29
    v_mul_f32 v30, v246, v30
    v_mul_f32 v31, v246, v31
    v_mfma_f32_16x16x32_bf16 a[236:239], a[248:251], v[200:203], a[236:239]
    s_waitcnt vmcnt(9)
    ds_read_b64_tr_b16 a[174:175], v224 offset:1280
    v_cvt_pk_bf16_f32 v29, v30, v31
    v_fma_f32 v195, v195, s32, v220
    v_exp_f32 v195, v195
    v_fma_f32 v196, v196, s32, v220
    v_mfma_f32_16x16x32_bf16 v[200:203], a[128:131], a[80:83], 0
    ds_write2_b64 v226, v[20:21], v[28:29] offset0:64 offset1:96
    v_cvt_pk_bf16_f32 v193, v194, v195
    v_accvgpr_read_b32 v254, a228
    v_mfma_f32_16x16x32_bf16 v[200:203], a[132:135], a[84:87], v[200:203]
    ds_read_b128 a[32:35], v248 offset:8192
    ds_read_b128 a[36:39], v248 offset:8448
    v_rcp_f32 v247, v254
    v_cmp_nge_f32 vcc, 0x4e800000, v254
    v_exp_f32 v196, v196
    v_mfma_f32_16x16x32_bf16 v[200:203], a[136:139], a[88:91], v[200:203]
    ds_read_b128 a[40:43], v248 offset:8704
    ds_read_b128 a[44:47], v248 offset:8960
    v_fma_f32 v197, v197, s32, v220
    v_mul_f32 v32, v247, v32
    v_mul_f32 v33, v247, v33
    v_cvt_pk_bf16_f32 v32, v32, v33
    v_mul_f32 v34, v247, v34
    v_mfma_f32_16x16x32_bf16 v[200:203], a[140:143], a[92:95], v[200:203]
    s_or_b64 s[50:51], s[50:51], vcc
    buffer_load_dwordx4 v251, s[16:19], s37 offen offset:1024 nt lds
    v_mul_f32 v35, v247, v35
    v_cvt_pk_bf16_f32 v33, v34, v35
    v_mul_f32 v40, v247, v40
    v_mfma_f32_16x16x32_bf16 v[204:207], a[144:147], a[80:83], 0
    s_add_u32 s36, s36, 0x800
    s_add_u32 s37, s37, 0x800
    v_xor_b32 v251, 32, v251
    v_mul_f32 v41, v247, v41
    v_cvt_pk_bf16_f32 v40, v40, v41
    v_mul_f32 v42, v247, v42
    v_mul_f32 v43, v247, v43
    v_cvt_pk_bf16_f32 v41, v42, v43
    v_mfma_f32_16x16x32_bf16 v[204:207], a[148:151], a[84:87], v[204:207]
    s_waitcnt lgkmcnt(15)
    v_exp_f32 v197, v197
    v_fma_f32 v198, v198, s32, v220
    v_exp_f32 v198, v198
    v_fma_f32 v199, v199, s32, v220
    v_exp_f32 v199, v199
    v_mfma_f32_16x16x32_bf16 v[204:207], a[152:155], a[88:91], v[204:207]
    ds_read_b64_tr_b16 a[176:177], v223 offset:512
    ds_read_b64_tr_b16 a[178:179], v223 offset:1536
    v_cvt_pk_bf16_f32 v194, v196, v197
    v_cvt_pk_bf16_f32 v195, v198, v199
    v_add_u32 v225, 0x1000, v225
    v_add_u32 v226, 0x1000, v226
    v_mfma_f32_16x16x32_bf16 v[204:207], a[156:159], a[92:95], v[204:207]
    ds_write2_b64 v225, v[32:33], v[40:41] offset0:0 offset1:32
    v_mul_f32 v36, v247, v36
    v_mfma_f32_16x16x32_bf16 v[128:131], a[192:195], v[192:195], v[128:131]
    v_mul_f32 v37, v247, v37
    v_cvt_pk_bf16_f32 v36, v36, v37
    v_mul_f32 v38, v247, v38
    v_mul_f32 v39, v247, v39
    v_cvt_pk_bf16_f32 v37, v38, v39
    v_mul_f32 v44, v247, v44
    v_mfma_f32_16x16x32_bf16 v[132:135], a[196:199], v[192:195], v[132:135]
    s_mov_b32 m0, s36
    v_mul_f32 v45, v247, v45
    v_cvt_pk_bf16_f32 v44, v44, v45
    v_mul_f32 v46, v247, v46
    v_mul_f32 v47, v247, v47
    v_cvt_pk_bf16_f32 v45, v46, v47
    v_fma_f32 v200, v200, s32, v221
    v_mfma_f32_16x16x32_bf16 v[136:139], a[200:203], v[192:195], v[136:139]
    buffer_load_dwordx4 v251, s[16:19], s37 offen nt lds
    ds_write2_b64 v226, v[36:37], v[44:45] offset0:0 offset1:32
    v_mfma_f32_16x16x32_bf16 v[140:143], a[204:207], v[192:195], v[140:143]
    ds_read_b64_tr_b16 a[180:181], v224 offset:512
    v_exp_f32 v200, v200
    v_mul_f32 v48, v247, v48
    v_mul_f32 v49, v247, v49
    v_cvt_pk_bf16_f32 v48, v48, v49
    v_mfma_f32_16x16x32_bf16 v[144:147], a[208:211], v[192:195], v[144:147]
    v_mul_f32 v50, v247, v50
    v_mul_f32 v51, v247, v51
    v_cvt_pk_bf16_f32 v49, v50, v51
    v_mul_f32 v56, v247, v56
    v_mul_f32 v57, v247, v57
    v_cvt_pk_bf16_f32 v56, v56, v57
    v_mfma_f32_16x16x32_bf16 v[148:151], a[212:215], v[192:195], v[148:151]
    v_mul_f32 v58, v247, v58
    v_mul_f32 v59, v247, v59
    v_cvt_pk_bf16_f32 v57, v58, v59
    v_fma_f32 v201, v201, s32, v221
    v_exp_f32 v201, v201
    v_mfma_f32_16x16x32_bf16 v[152:155], a[216:219], v[192:195], v[152:155]
    ds_write2_b64 v225, v[48:49], v[56:57] offset0:64 offset1:96
    v_cvt_pk_bf16_f32 v200, v200, v201
    v_fma_f32 v202, v202, s32, v221
    v_mfma_f32_16x16x32_bf16 v[156:159], a[220:223], v[192:195], v[156:159]
    ds_read_b64_tr_b16 a[182:183], v224 offset:1536
    v_exp_f32 v202, v202
    v_mul_f32 v52, v247, v52
    v_mul_f32 v53, v247, v53
    v_cvt_pk_bf16_f32 v52, v52, v53
    v_mul_f32 v54, v247, v54
    v_mfma_f32_16x16x32_bf16 a[240:243], a[248:251], v[192:195], a[240:243]
    s_waitcnt lgkmcnt(15)
    v_mul_f32 v55, v247, v55
    v_cvt_pk_bf16_f32 v53, v54, v55
    v_mul_f32 v60, v247, v60
    v_mul_f32 v61, v247, v61
    v_cvt_pk_bf16_f32 v60, v60, v61
    v_mul_f32 v62, v247, v62
    v_mul_f32 v63, v247, v63
    v_mfma_f32_16x16x32_bf16 v[192:195], a[96:99], a[0:3], 0
    buffer_load_dwordx4 v251, s[16:19], s37 offen offset:1024 nt lds
    ds_read_b64_tr_b16 a[184:185], v223 offset:768
    v_cvt_pk_bf16_f32 v61, v62, v63
    v_fma_f32 v203, v203, s32, v221
    v_mfma_f32_16x16x32_bf16 v[192:195], a[100:103], a[4:7], v[192:195]
    s_add_u32 s36, s36, 0x800
    ds_write2_b64 v226, v[52:53], v[60:61] offset0:64 offset1:96
    s_add_u32 s37, s37, 0x800
    v_xor_b32 v251, 32, v251
    v_mfma_f32_16x16x32_bf16 v[192:195], a[104:107], a[8:11], v[192:195]
    s_xor_b32 m0, s35, 0x8000
    v_exp_f32 v203, v203
    v_fma_f32 v204, v204, s32, v221
    v_accvgpr_read_b32 v254, a232
    v_rcp_f32 v246, v254
    v_cmp_nge_f32 vcc, 0x4e800000, v254
    v_mfma_f32_16x16x32_bf16 v[192:195], a[108:111], a[12:15], v[192:195]
    buffer_load_dwordx4 v250, s[12:15], s34 offen nt lds
    v_cvt_pk_bf16_f32 v201, v202, v203
    v_exp_f32 v204, v204
    v_mfma_f32_16x16x32_bf16 v[196:199], a[112:115], a[0:3], 0
    s_or_b64 s[50:51], s[50:51], vcc
    ds_read_b64_tr_b16 a[186:187], v223 offset:1792
    v_fma_f32 v205, v205, s32, v221
    v_mul_f32 v64, v246, v64
    v_mul_f32 v65, v246, v65
    v_cvt_pk_bf16_f32 v64, v64, v65
    v_mul_f32 v66, v246, v66
    v_mul_f32 v67, v246, v67
    v_mfma_f32_16x16x32_bf16 v[196:199], a[116:119], a[4:7], v[196:199]
    v_exp_f32 v205, v205
    v_fma_f32 v206, v206, s32, v221
    v_exp_f32 v206, v206
    v_fma_f32 v207, v207, s32, v221
    v_exp_f32 v207, v207
    v_mfma_f32_16x16x32_bf16 v[196:199], a[120:123], a[8:11], v[196:199]
    s_waitcnt vmcnt(9)
    v_cvt_pk_bf16_f32 v202, v204, v205
    v_cvt_pk_bf16_f32 v203, v206, v207
    v_cvt_pk_bf16_f32 v65, v66, v67
    v_mul_f32 v72, v246, v72
    v_mul_f32 v73, v246, v73
    v_cvt_pk_bf16_f32 v72, v72, v73
    v_mfma_f32_16x16x32_bf16 v[196:199], a[124:127], a[12:15], v[196:199]
    ds_read_b64_tr_b16 a[188:189], v224 offset:768
    v_mul_f32 v74, v246, v74
    v_mul_f32 v75, v246, v75
    v_cvt_pk_bf16_f32 v73, v74, v75
    v_add_u32 v225, 0x1000, v225
    v_add_u32 v226, 0x1000, v226
    v_mfma_f32_16x16x32_bf16 v[160:163], a[192:195], v[200:203], v[160:163]
    buffer_load_dwordx4 v250, s[12:15], s34 offen offset:1024 nt lds
    ds_write2_b64 v225, v[64:65], v[72:73] offset0:0 offset1:32
    v_mfma_f32_16x16x32_bf16 v[164:167], a[196:199], v[200:203], v[164:167]
    v_mul_f32 v68, v246, v68
    v_mul_f32 v69, v246, v69
    v_cvt_pk_bf16_f32 v68, v68, v69
    v_mul_f32 v70, v246, v70
    v_mul_f32 v71, v246, v71
    v_cvt_pk_bf16_f32 v69, v70, v71
    v_mfma_f32_16x16x32_bf16 v[168:171], a[200:203], v[200:203], v[168:171]
    s_mov_b32 m0, s35
    ds_read_b64_tr_b16 a[190:191], v224 offset:1792
    v_mul_f32 v76, v246, v76
    v_mul_f32 v77, v246, v77
    v_cvt_pk_bf16_f32 v76, v76, v77
    v_mul_f32 v78, v246, v78
    v_mul_f32 v79, v246, v79
    v_cvt_pk_bf16_f32 v77, v78, v79
    v_mfma_f32_16x16x32_bf16 v[172:175], a[204:207], v[200:203], v[172:175]
    ds_write2_b64 v226, v[68:69], v[76:77] offset0:0 offset1:32
    v_max3_f32 v216, v192, v193, v194
    v_max3_f32 v216, v216, v195, v196
    v_mfma_f32_16x16x32_bf16 v[176:179], a[208:211], v[200:203], v[176:179]
    ds_read_b128 a[48:51], v248 offset:12288
    ds_read_b128 a[52:55], v248 offset:12544
    v_max3_f32 v216, v216, v197, v198
    v_max_f32 v216, v216, v199
    v_mov_b32 v252, v216
    v_mul_f32 v80, v246, v80
    v_mul_f32 v81, v246, v81
    v_cvt_pk_bf16_f32 v80, v80, v81
    v_mul_f32 v82, v246, v82
    v_mfma_f32_16x16x32_bf16 v[180:183], a[212:215], v[200:203], v[180:183]
    buffer_load_dwordx4 v249, s[8:11], s34 offen nt lds
    ds_read_b128 a[56:59], v248 offset:12800
    ds_read_b128 a[60:63], v248 offset:13056
    v_permlane16_swap_b32 v252, v216
    v_max_f32 v216, v216, v252
    v_mfma_f32_16x16x32_bf16 v[184:187], a[216:219], v[200:203], v[184:187]
    v_mov_b32 v252, v216
    v_mul_f32 v83, v246, v83
    v_cvt_pk_bf16_f32 v81, v82, v83
    v_mul_f32 v88, v246, v88
    v_mul_f32 v89, v246, v89
    v_cvt_pk_bf16_f32 v88, v88, v89
    v_mul_f32 v90, v246, v90
    v_mul_f32 v91, v246, v91
    v_cvt_pk_bf16_f32 v89, v90, v91
    v_mfma_f32_16x16x32_bf16 v[188:191], a[220:223], v[200:203], v[188:191]
    ds_write2_b64 v225, v[80:81], v[88:89] offset0:64 offset1:96
    v_permlane32_swap_b32 v252, v216
    v_max_f32 v216, v216, v252
    v_mul_f32 v216, s33, v216
    v_mfma_f32_16x16x32_bf16 a[244:247], a[248:251], v[200:203], a[244:247]
    s_waitcnt lgkmcnt(15)
    v_fma_f32 v192, v192, s32, v216
    v_exp_f32 v192, v192
    v_fma_f32 v193, v193, s32, v216
    v_exp_f32 v193, v193
    v_fma_f32 v194, v194, s32, v216
    v_exp_f32 v194, v194
    v_mul_f32 v84, v246, v84
    v_mfma_f32_16x16x32_bf16 v[200:203], a[96:99], a[16:19], 0
    v_cvt_pk_bf16_f32 v192, v192, v193
    v_mul_f32 v85, v246, v85
    v_cvt_pk_bf16_f32 v84, v84, v85
    v_mul_f32 v86, v246, v86
    v_mul_f32 v87, v246, v87
    v_cvt_pk_bf16_f32 v85, v86, v87
    v_mul_f32 v92, v246, v92
    v_mul_f32 v93, v246, v93
    v_cvt_pk_bf16_f32 v92, v92, v93
    v_mul_f32 v94, v246, v94
    v_mfma_f32_16x16x32_bf16 v[200:203], a[100:103], a[20:23], v[200:203]
    buffer_load_dwordx4 v249, s[8:11], s34 offen offset:1024 nt lds
    v_mul_f32 v95, v246, v95
    v_cvt_pk_bf16_f32 v93, v94, v95
    v_fma_f32 v195, v195, s32, v216
    v_exp_f32 v195, v195
    v_fma_f32 v196, v196, s32, v216
    v_mfma_f32_16x16x32_bf16 v[200:203], a[104:107], a[24:27], v[200:203]
    s_add_u32 s34, s34, 0x2000
    ds_write2_b64 v226, v[84:85], v[92:93] offset0:64 offset1:96
    v_cvt_pk_bf16_f32 v193, v194, v195
    v_accvgpr_read_b32 v254, a236
    v_rcp_f32 v247, v254
    v_cmp_nge_f32 vcc, 0x4e800000, v254
    v_mfma_f32_16x16x32_bf16 v[200:203], a[108:111], a[28:31], v[200:203]
    s_xor_b32 s35, s35, 0x6000
    v_exp_f32 v196, v196
    v_fma_f32 v197, v197, s32, v216
    v_exp_f32 v197, v197
    v_fma_f32 v198, v198, s32, v216
    v_exp_f32 v198, v198
    v_fma_f32 v199, v199, s32, v216
    v_exp_f32 v199, v199
    v_mfma_f32_16x16x32_bf16 v[204:207], a[112:115], a[16:19], 0
    s_or_b64 s[50:51], s[50:51], vcc
    v_cvt_pk_bf16_f32 v194, v196, v197
    v_cvt_pk_bf16_f32 v195, v198, v199
    v_mul_f32 v96, v247, v96
    v_mul_f32 v97, v247, v97
    v_cvt_pk_bf16_f32 v96, v96, v97
    v_mfma_f32_16x16x32_bf16 v[204:207], a[116:119], a[20:23], v[204:207]
    s_waitcnt vmcnt(22) lgkmcnt(7)
    v_mfma_f32_16x16x32_bf16 v[204:207], a[120:123], a[24:27], v[204:207]
    s_barrier
    v_mfma_f32_16x16x32_bf16 v[204:207], a[124:127], a[28:31], v[204:207]
    v_mul_f32 v98, v247, v98
    v_mul_f32 v99, v247, v99
    v_cvt_pk_bf16_f32 v97, v98, v99
    v_mul_f32 v104, v247, v104
    v_mul_f32 v105, v247, v105
    v_mfma_f32_16x16x32_bf16 v[0:3], a[160:163], v[192:195], 0
    v_cvt_pk_bf16_f32 v104, v104, v105
    v_mul_f32 v106, v247, v106
    v_mul_f32 v107, v247, v107
    v_cvt_pk_bf16_f32 v105, v106, v107
    v_add_u32 v225, 0x1000, v225
    v_mfma_f32_16x16x32_bf16 v[4:7], a[164:167], v[192:195], 0
    v_add_u32 v226, 0x1000, v226
    v_mul_f32 v100, v247, v100
    v_mul_f32 v101, v247, v101
    v_cvt_pk_bf16_f32 v100, v100, v101
    v_mul_f32 v102, v247, v102
    v_mfma_f32_16x16x32_bf16 v[8:11], a[168:171], v[192:195], 0
    ds_write2_b64 v225, v[96:97], v[104:105] offset0:0 offset1:32
    v_mul_f32 v103, v247, v103
    v_mfma_f32_16x16x32_bf16 v[12:15], a[172:175], v[192:195], 0
    s_xor_b32 m0, s35, 0x8000
    v_cvt_pk_bf16_f32 v101, v102, v103
    v_mul_f32 v108, v247, v108
    v_mul_f32 v109, v247, v109
    v_cvt_pk_bf16_f32 v108, v108, v109
    v_mul_f32 v110, v247, v110
    v_mul_f32 v111, v247, v111
    v_mfma_f32_16x16x32_bf16 v[16:19], a[176:179], v[192:195], 0
    buffer_load_dwordx4 v250, s[12:15], s34 offen nt lds
    v_cvt_pk_bf16_f32 v109, v110, v111
    v_max3_f32 v217, v200, v201, v202
    v_max3_f32 v217, v217, v203, v204
    v_max3_f32 v217, v217, v205, v206
    v_mfma_f32_16x16x32_bf16 v[20:23], a[180:183], v[192:195], 0
    ds_write2_b64 v226, v[100:101], v[108:109] offset0:0 offset1:32
    v_max_f32 v217, v217, v207
    v_mov_b32 v252, v217
    v_mul_f32 v112, v247, v112
    v_mfma_f32_16x16x32_bf16 v[24:27], a[184:187], v[192:195], 0
    v_permlane16_swap_b32 v252, v217
    v_max_f32 v217, v217, v252
    v_mov_b32 v252, v217
    v_mul_f32 v113, v247, v113
    v_cvt_pk_bf16_f32 v112, v112, v113
    v_mul_f32 v114, v247, v114
    v_mul_f32 v115, v247, v115
    v_mfma_f32_16x16x32_bf16 v[28:31], a[188:191], v[192:195], 0
    s_waitcnt vmcnt(9)
    v_permlane32_swap_b32 v252, v217
    v_max_f32 v217, v217, v252
    v_mul_f32 v217, s33, v217
    v_fma_f32 v200, v200, s32, v217
    v_exp_f32 v200, v200
    v_cvt_pk_bf16_f32 v113, v114, v115
    v_mul_f32 v120, v247, v120
    v_mfma_f32_16x16x32_bf16 a[224:227], a[248:251], v[192:195], 0
    s_waitcnt lgkmcnt(15)
    v_mul_f32 v121, v247, v121
    v_cvt_pk_bf16_f32 v120, v120, v121
    v_mul_f32 v122, v247, v122
    v_mul_f32 v123, v247, v123
    v_cvt_pk_bf16_f32 v121, v122, v123
    v_fma_f32 v201, v201, s32, v217
    v_exp_f32 v201, v201
    v_fma_f32 v202, v202, s32, v217
    v_mfma_f32_16x16x32_bf16 v[192:195], a[96:99], a[32:35], 0
    buffer_load_dwordx4 v250, s[12:15], s34 offen offset:1024 nt lds
    ds_write2_b64 v225, v[112:113], v[120:121] offset0:64 offset1:96
    v_mfma_f32_16x16x32_bf16 v[192:195], a[100:103], a[36:39], v[192:195]
    ds_read_b128 a[128:131], v222 offset:8192
    v_cvt_pk_bf16_f32 v200, v200, v201
    v_exp_f32 v202, v202
    v_mul_f32 v116, v247, v116
    v_mul_f32 v117, v247, v117
    v_cvt_pk_bf16_f32 v116, v116, v117
    v_mul_f32 v118, v247, v118
    v_mul_f32 v119, v247, v119
    v_mfma_f32_16x16x32_bf16 v[192:195], a[104:107], a[40:43], v[192:195]
    s_mov_b32 m0, s35
    v_cvt_pk_bf16_f32 v117, v118, v119
    v_mul_f32 v124, v247, v124
    v_mul_f32 v125, v247, v125
    v_cvt_pk_bf16_f32 v124, v124, v125
    v_mul_f32 v126, v247, v126
    v_mul_f32 v127, v247, v127
    v_cvt_pk_bf16_f32 v125, v126, v127
    v_fma_f32 v203, v203, s32, v217
    v_fma_f32 v204, v204, s32, v217
    v_mfma_f32_16x16x32_bf16 v[192:195], a[108:111], a[44:47], v[192:195]
    ds_write2_b64 v226, v[116:117], v[124:125] offset0:64 offset1:96
    v_exp_f32 v203, v203
    v_accvgpr_read_b32 v254, a240
    v_fma_f32 v205, v205, s32, v217
    v_mfma_f32_16x16x32_bf16 v[196:199], a[112:115], a[32:35], 0
    ds_read_b128 a[132:135], v222 offset:8448
    ds_read_b128 a[64:67], v248 offset:16384
    v_cvt_pk_bf16_f32 v201, v202, v203
    v_rcp_f32 v246, v254
    v_cmp_nge_f32 vcc, 0x4e800000, v254
    v_exp_f32 v204, v204
    v_add_u32 v225, 0x1000, v225
    v_mfma_f32_16x16x32_bf16 v[196:199], a[116:119], a[36:39], v[196:199]
    buffer_load_dwordx4 v249, s[8:11], s34 offen nt lds
    v_exp_f32 v205, v205
    v_fma_f32 v206, v206, s32, v217
    v_exp_f32 v206, v206
    v_fma_f32 v207, v207, s32, v217
    v_exp_f32 v207, v207
    v_mfma_f32_16x16x32_bf16 v[196:199], a[120:123], a[40:43], v[196:199]
    s_or_b64 s[50:51], s[50:51], vcc
    ds_read_b128 a[68:71], v248 offset:16640
    v_cvt_pk_bf16_f32 v202, v204, v205
    v_cvt_pk_bf16_f32 v203, v206, v207
    v_mul_f32 v128, v246, v128
    v_mfma_f32_16x16x32_bf16 v[196:199], a[124:127], a[44:47], v[196:199]
    ds_read_b128 a[72:75], v248 offset:16896
    v_mul_f32 v129, v246, v129
    v_cvt_pk_bf16_f32 v128, v128, v129
    v_mul_f32 v130, v246, v130
    v_mfma_f32_16x16x32_bf16 v[32:35], a[160:163], v[200:203], 0
    ds_read_b128 a[76:79], v248 offset:17152
    v_mul_f32 v131, v246, v131
    v_cvt_pk_bf16_f32 v129, v130, v131
    v_mul_f32 v136, v246, v136
    v_mul_f32 v137, v246, v137
    v_mfma_f32_16x16x32_bf16 v[36:39], a[164:167], v[200:203], 0
    v_cvt_pk_bf16_f32 v136, v136, v137
    v_mul_f32 v138, v246, v138
    v_mul_f32 v139, v246, v139
    v_cvt_pk_bf16_f32 v137, v138, v139
    v_add_u32 v226, 0x1000, v226
    v_mfma_f32_16x16x32_bf16 v[40:43], a[168:171], v[200:203], 0
    buffer_load_dwordx4 v249, s[8:11], s34 offen offset:1024 nt lds
    ds_write2_b64 v225, v[128:129], v[136:137] offset0:0 offset1:32
    v_mfma_f32_16x16x32_bf16 v[44:47], a[172:175], v[200:203], 0
    s_add_u32 s34, s34, 0x2000
    ds_read_b128 a[136:139], v222 offset:8704
    v_mul_f32 v132, v246, v132
    v_mul_f32 v133, v246, v133
    v_cvt_pk_bf16_f32 v132, v132, v133
    v_mul_f32 v134, v246, v134
    v_mfma_f32_16x16x32_bf16 v[48:51], a[176:179], v[200:203], 0
    s_xor_b32 s35, s35, 0x2000
    v_mul_f32 v135, v246, v135
    v_cvt_pk_bf16_f32 v133, v134, v135
    v_mul_f32 v140, v246, v140
    v_mul_f32 v141, v246, v141
    v_cvt_pk_bf16_f32 v140, v140, v141
    v_mul_f32 v142, v246, v142
    v_mul_f32 v143, v246, v143
    v_mfma_f32_16x16x32_bf16 v[52:55], a[180:183], v[200:203], 0
    ds_read_b128 a[140:143], v222 offset:8960
    v_cvt_pk_bf16_f32 v141, v142, v143
    v_max3_f32 v218, v192, v193, v194
    v_max3_f32 v218, v218, v195, v196
    v_max3_f32 v218, v218, v197, v198
    v_max_f32 v218, v218, v199
    v_mov_b32 v252, v218
    v_mul_f32 v144, v246, v144
    v_mfma_f32_16x16x32_bf16 v[56:59], a[184:187], v[200:203], 0
    ds_write2_b64 v226, v[132:133], v[140:141] offset0:0 offset1:32
    v_permlane16_swap_b32 v252, v218
    v_max_f32 v218, v218, v252
    v_mfma_f32_16x16x32_bf16 v[60:63], a[188:191], v[200:203], 0
    v_mov_b32 v252, v218
    v_mul_f32 v145, v246, v145
    v_cvt_pk_bf16_f32 v144, v144, v145
    v_mul_f32 v146, v246, v146
    v_mul_f32 v147, v246, v147
    v_cvt_pk_bf16_f32 v145, v146, v147
    v_mul_f32 v152, v246, v152
    v_mul_f32 v153, v246, v153
    v_mfma_f32_16x16x32_bf16 a[228:231], a[248:251], v[200:203], 0
    s_waitcnt lgkmcnt(15)
    v_permlane32_swap_b32 v252, v218
    v_max_f32 v218, v218, v252
    v_mul_f32 v218, s33, v218
    v_fma_f32 v192, v192, s32, v218
    v_exp_f32 v192, v192
    v_cvt_pk_bf16_f32 v152, v152, v153
    v_mfma_f32_16x16x32_bf16 v[200:203], a[96:99], a[48:51], 0
    ds_read_b128 a[144:147], v222 offset:9216
    v_mul_f32 v154, v246, v154
    v_mul_f32 v155, v246, v155
    v_cvt_pk_bf16_f32 v153, v154, v155
    v_fma_f32 v193, v193, s32, v218
    v_exp_f32 v193, v193
    v_fma_f32 v194, v194, s32, v218
    v_mfma_f32_16x16x32_bf16 v[200:203], a[100:103], a[52:55], v[200:203]
    ds_write2_b64 v225, v[144:145], v[152:153] offset0:64 offset1:96
    v_cvt_pk_bf16_f32 v192, v192, v193
    v_exp_f32 v194, v194
    v_mfma_f32_16x16x32_bf16 v[200:203], a[104:107], a[56:59], v[200:203]
    v_mul_f32 v148, v246, v148
    v_mul_f32 v149, v246, v149
    v_cvt_pk_bf16_f32 v148, v148, v149
    v_mul_f32 v150, v246, v150
    v_mul_f32 v151, v246, v151
    v_cvt_pk_bf16_f32 v149, v150, v151
    v_mul_f32 v156, v246, v156
    v_mul_f32 v157, v246, v157
    v_mfma_f32_16x16x32_bf16 v[200:203], a[108:111], a[60:63], v[200:203]
    ds_read_b128 a[148:151], v222 offset:9472
    v_cvt_pk_bf16_f32 v156, v156, v157
    v_mul_f32 v158, v246, v158
    v_mul_f32 v159, v246, v159
    v_cvt_pk_bf16_f32 v157, v158, v159
    v_fma_f32 v195, v195, s32, v218
    v_exp_f32 v195, v195
    v_mfma_f32_16x16x32_bf16 v[204:207], a[112:115], a[48:51], 0
    ds_write2_b64 v226, v[148:149], v[156:157] offset0:64 offset1:96
    v_cvt_pk_bf16_f32 v193, v194, v195
    v_fma_f32 v196, v196, s32, v218
    v_accvgpr_read_b32 v254, a244
    v_mfma_f32_16x16x32_bf16 v[204:207], a[116:119], a[52:55], v[204:207]
    v_exp_f32 v196, v196
    v_fma_f32 v197, v197, s32, v218
    v_exp_f32 v197, v197
    v_fma_f32 v198, v198, s32, v218
    v_exp_f32 v198, v198
    v_fma_f32 v199, v199, s32, v218
    v_exp_f32 v199, v199
    v_mfma_f32_16x16x32_bf16 v[204:207], a[120:123], a[56:59], v[204:207]
    v_cvt_pk_bf16_f32 v194, v196, v197
    v_cvt_pk_bf16_f32 v195, v198, v199
    v_mfma_f32_16x16x32_bf16 v[204:207], a[124:127], a[60:63], v[204:207]
    ds_read_b128 v[228:231], v227 offset:0
    ds_read_b128 v[232:235], v227 offset:1024
    ds_read_b128 v[236:239], v227 offset:2048
    ds_read_b128 v[240:243], v227 offset:3072
    v_mfma_f32_16x16x32_bf16 v[64:67], a[160:163], v[192:195], 0
    v_rcp_f32 v247, v254
    v_mfma_f32_16x16x32_bf16 v[68:71], a[164:167], v[192:195], 0
    s_waitcnt vmcnt(8)
    v_cmp_nge_f32 vcc, 0x4e800000, v254
    v_mul_f32 v160, v247, v160
    v_mul_f32 v161, v247, v161
    v_cvt_pk_bf16_f32 v160, v160, v161
    v_mul_f32 v162, v247, v162
    v_mul_f32 v163, v247, v163
    v_cvt_pk_bf16_f32 v161, v162, v163
    v_mul_f32 v168, v247, v168
    v_mul_f32 v169, v247, v169
    v_mfma_f32_16x16x32_bf16 v[72:75], a[168:171], v[192:195], 0
    ds_read_b128 a[152:155], v222 offset:9728
    v_cvt_pk_bf16_f32 v168, v168, v169
    v_mul_f32 v170, v247, v170
    v_mul_f32 v171, v247, v171
    v_cvt_pk_bf16_f32 v169, v170, v171
    v_add_u32 v225, 0x1000, v225
    v_add_u32 v226, 0x1000, v226
    v_add_u32 v227, 0x1000, v227
    v_mul_f32 v164, v247, v164
    v_mfma_f32_16x16x32_bf16 v[76:79], a[172:175], v[192:195], 0
    s_waitcnt lgkmcnt(4)
    buffer_store_dwordx4 v[228:231], v244, s[20:23], s40 offen nt
    v_mul_f32 v165, v247, v165
    v_cvt_pk_bf16_f32 v164, v164, v165
    v_mfma_f32_16x16x32_bf16 v[80:83], a[176:179], v[192:195], 0
    s_or_b64 s[50:51], s[50:51], vcc
    v_mul_f32 v166, v247, v166
    v_mul_f32 v167, v247, v167
    v_cvt_pk_bf16_f32 v165, v166, v167
    v_mul_f32 v172, v247, v172
    v_mul_f32 v173, v247, v173
    v_cvt_pk_bf16_f32 v172, v172, v173
    v_mul_f32 v174, v247, v174
    v_mul_f32 v175, v247, v175
    v_cvt_pk_bf16_f32 v173, v174, v175
    v_mfma_f32_16x16x32_bf16 v[84:87], a[180:183], v[192:195], 0
    ds_read_b128 a[156:159], v222 offset:9984
    v_max3_f32 v219, v200, v201, v202
    v_max3_f32 v219, v219, v203, v204
    v_max3_f32 v219, v219, v205, v206
    v_max_f32 v219, v219, v207
    v_mov_b32 v252, v219
    v_mul_f32 v176, v247, v176
    v_mul_f32 v177, v247, v177
    v_cvt_pk_bf16_f32 v176, v176, v177
    v_mfma_f32_16x16x32_bf16 v[88:91], a[184:187], v[192:195], 0
    v_permlane16_swap_b32 v252, v219
    v_max_f32 v219, v219, v252
    v_mov_b32 v252, v219
    v_mul_f32 v178, v247, v178
    v_mul_f32 v179, v247, v179
    v_cvt_pk_bf16_f32 v177, v178, v179
    v_mul_f32 v184, v247, v184
    v_mul_f32 v185, v247, v185
    v_cvt_pk_bf16_f32 v184, v184, v185
    v_mfma_f32_16x16x32_bf16 v[92:95], a[188:191], v[192:195], 0
    v_permlane32_swap_b32 v252, v219
    v_max_f32 v219, v219, v252
    v_mul_f32 v219, s33, v219
    v_fma_f32 v200, v200, s32, v219
    v_exp_f32 v200, v200
    v_mul_f32 v186, v247, v186
    v_mul_f32 v187, v247, v187
    v_cvt_pk_bf16_f32 v185, v186, v187
    v_mfma_f32_16x16x32_bf16 a[232:235], a[248:251], v[192:195], 0
    s_waitcnt lgkmcnt(2)
    buffer_store_dwordx4 v[232:235], v245, s[20:23], s40 offen offset:1024 nt
    ds_read_b128 a[80:83], v248 offset:20480
    ds_read_b128 a[84:87], v248 offset:20736
    v_fma_f32 v201, v201, s32, v219
    v_mfma_f32_16x16x32_bf16 v[192:195], a[96:99], a[64:67], 0
    ds_read_b128 a[88:91], v248 offset:20992
    ds_read_b128 a[92:95], v248 offset:21248
    ds_read_b64_tr_b16 a[192:193], v223 offset:8192
    v_exp_f32 v201, v201
    v_fma_f32 v202, v202, s32, v219
    v_exp_f32 v202, v202
    v_mul_f32 v180, v247, v180
    v_mul_f32 v181, v247, v181
    v_mfma_f32_16x16x32_bf16 v[192:195], a[100:103], a[68:71], v[192:195]
    ds_write2_b64 v225, v[160:161], v[168:169] offset0:0 offset1:32
    v_cvt_pk_bf16_f32 v200, v200, v201
    v_cvt_pk_bf16_f32 v180, v180, v181
    v_mul_f32 v182, v247, v182
    v_mul_f32 v183, v247, v183
    v_cvt_pk_bf16_f32 v181, v182, v183
    v_mfma_f32_16x16x32_bf16 v[192:195], a[104:107], a[72:75], v[192:195]
    ds_write2_b64 v226, v[164:165], v[172:173] offset0:0 offset1:32
    v_mul_f32 v188, v247, v188
    v_mul_f32 v189, v247, v189
    v_cvt_pk_bf16_f32 v188, v188, v189
    v_mul_f32 v190, v247, v190
    v_mul_f32 v191, v247, v191
    v_mfma_f32_16x16x32_bf16 v[192:195], a[108:111], a[76:79], v[192:195]
    ds_read_b64_tr_b16 a[194:195], v223 offset:9216
    ds_write2_b64 v225, v[176:177], v[184:185] offset0:64 offset1:96
    v_cvt_pk_bf16_f32 v189, v190, v191
    v_fma_f32 v203, v203, s32, v219
    v_exp_f32 v203, v203
    v_mfma_f32_16x16x32_bf16 v[196:199], a[112:115], a[64:67], 0
    buffer_store_dwordx4 v[236:239], v244, s[20:23], s40 offen offset:2048 nt
    ds_write2_b64 v226, v[180:181], v[188:189] offset0:64 offset1:96
    v_mfma_f32_16x16x32_bf16 v[196:199], a[116:119], a[68:71], v[196:199]
    v_fma_f32 v204, v204, s32, v219
    v_exp_f32 v204, v204
    v_fma_f32 v205, v205, s32, v219
    v_exp_f32 v205, v205
    v_fma_f32 v206, v206, s32, v219
    v_exp_f32 v206, v206
    v_fma_f32 v207, v207, s32, v219
    v_exp_f32 v207, v207
    v_mfma_f32_16x16x32_bf16 v[196:199], a[120:123], a[72:75], v[196:199]
    v_cvt_pk_bf16_f32 v201, v202, v203
    v_cvt_pk_bf16_f32 v202, v204, v205
    v_cvt_pk_bf16_f32 v203, v206, v207
    v_mfma_f32_16x16x32_bf16 v[196:199], a[124:127], a[76:79], v[196:199]
    ds_read_b64_tr_b16 a[196:197], v224 offset:8192
    v_add_u32 v225, 0xffffb000, v225
    v_mfma_f32_16x16x32_bf16 v[96:99], a[160:163], v[200:203], 0
    ds_read_b64_tr_b16 a[198:199], v224 offset:9216
    v_add_u32 v226, 0xffffb000, v226
    v_mfma_f32_16x16x32_bf16 v[100:103], a[164:167], v[200:203], 0
    buffer_store_dwordx4 v[240:243], v245, s[20:23], s40 offen offset:3072 nt
    v_mfma_f32_16x16x32_bf16 v[104:107], a[168:171], v[200:203], 0
    s_add_u32 s40, s40, 0x1000
    ds_read_b64_tr_b16 a[200:201], v223 offset:8448
    v_max3_f32 v220, v192, v193, v194
    v_mfma_f32_16x16x32_bf16 v[108:111], a[172:175], v[200:203], 0
    v_max3_f32 v220, v220, v195, v196
    v_max3_f32 v220, v220, v197, v198
    v_mfma_f32_16x16x32_bf16 v[112:115], a[176:179], v[200:203], 0
    v_max_f32 v220, v220, v199
    v_mov_b32 v252, v220
    v_mfma_f32_16x16x32_bf16 v[116:119], a[180:183], v[200:203], 0
    s_nop 0
    v_permlane16_swap_b32 v252, v220
    v_max_f32 v220, v220, v252
    v_mfma_f32_16x16x32_bf16 v[120:123], a[184:187], v[200:203], 0
    ds_read_b64_tr_b16 a[202:203], v223 offset:9472
    ds_read_b64_tr_b16 a[204:205], v224 offset:8448
    v_mov_b32 v252, v220
    v_mfma_f32_16x16x32_bf16 v[124:127], a[188:191], v[200:203], 0
    s_nop 0
    v_permlane32_swap_b32 v252, v220
    v_max_f32 v220, v220, v252
    v_mfma_f32_16x16x32_bf16 a[236:239], a[248:251], v[200:203], 0
    s_waitcnt lgkmcnt(11)
    v_mul_f32 v220, s33, v220
    v_fma_f32 v192, v192, s32, v220
    v_fma_f32 v193, v193, s32, v220
    v_mfma_f32_16x16x32_bf16 v[200:203], a[96:99], a[80:83], 0
    v_exp_f32 v192, v192
    v_exp_f32 v193, v193
    v_mfma_f32_16x16x32_bf16 v[200:203], a[100:103], a[84:87], v[200:203]
    v_cvt_pk_bf16_f32 v192, v192, v193
    v_fma_f32 v194, v194, s32, v220
    v_exp_f32 v194, v194
    v_mfma_f32_16x16x32_bf16 v[200:203], a[104:107], a[88:91], v[200:203]
    v_fma_f32 v195, v195, s32, v220
    v_exp_f32 v195, v195
    v_fma_f32 v196, v196, s32, v220
    v_mfma_f32_16x16x32_bf16 v[200:203], a[108:111], a[92:95], v[200:203]
    ds_read_b64_tr_b16 a[206:207], v224 offset:9472
    v_cvt_pk_bf16_f32 v193, v194, v195
    v_exp_f32 v196, v196
    v_mfma_f32_16x16x32_bf16 v[204:207], a[112:115], a[80:83], 0
    ds_read_b64_tr_b16 a[208:209], v223 offset:8704
    v_fma_f32 v197, v197, s32, v220
    v_exp_f32 v197, v197
    v_mfma_f32_16x16x32_bf16 v[204:207], a[116:119], a[84:87], v[204:207]
    s_waitcnt lgkmcnt(15)
    v_fma_f32 v198, v198, s32, v220
    v_exp_f32 v198, v198
    v_fma_f32 v199, v199, s32, v220
    v_exp_f32 v199, v199
    v_mfma_f32_16x16x32_bf16 v[204:207], a[120:123], a[88:91], v[204:207]
    v_cvt_pk_bf16_f32 v194, v196, v197
    v_cvt_pk_bf16_f32 v195, v198, v199
    v_mfma_f32_16x16x32_bf16 v[204:207], a[124:127], a[92:95], v[204:207]
    ds_read_b64_tr_b16 a[210:211], v223 offset:9728
    ds_read_b64_tr_b16 a[212:213], v224 offset:8704
    v_mfma_f32_16x16x32_bf16 v[128:131], a[160:163], v[192:195], 0
    ds_read_b64_tr_b16 a[214:215], v224 offset:9728
    ds_read_b64_tr_b16 a[216:217], v223 offset:8960
    v_mfma_f32_16x16x32_bf16 v[132:135], a[164:167], v[192:195], 0
    ds_read_b64_tr_b16 a[218:219], v223 offset:9984
    ds_read_b64_tr_b16 a[220:221], v224 offset:8960
    v_mfma_f32_16x16x32_bf16 v[136:139], a[168:171], v[192:195], 0
    v_max3_f32 v221, v200, v201, v202
    v_max3_f32 v221, v221, v203, v204
    v_mfma_f32_16x16x32_bf16 v[140:143], a[172:175], v[192:195], 0
    v_max3_f32 v221, v221, v205, v206
    v_max_f32 v221, v221, v207
    v_mfma_f32_16x16x32_bf16 v[144:147], a[176:179], v[192:195], 0
    ds_read_b64_tr_b16 a[222:223], v224 offset:9984
    v_mov_b32 v252, v221
    v_mfma_f32_16x16x32_bf16 v[148:151], a[180:183], v[192:195], 0
    s_nop 0
    v_permlane16_swap_b32 v252, v221
    v_mfma_f32_16x16x32_bf16 v[152:155], a[184:187], v[192:195], 0
    v_max_f32 v221, v221, v252
    v_mov_b32 v252, v221
    v_xor_b32 v222, 0x4000, v222
    v_mfma_f32_16x16x32_bf16 v[156:159], a[188:191], v[192:195], 0
    v_permlane32_swap_b32 v252, v221
    v_max_f32 v221, v221, v252
    v_mfma_f32_16x16x32_bf16 a[240:243], a[248:251], v[192:195], 0
    v_mul_f32 v221, s33, v221
    v_fma_f32 v200, v200, s32, v221
    v_fma_f32 v201, v201, s32, v221
    v_mfma_f32_16x16x32_bf16 v[192:195], a[128:131], a[0:3], 0
    v_exp_f32 v200, v200
    v_fma_f32 v202, v202, s32, v221
    v_mfma_f32_16x16x32_bf16 v[192:195], a[132:135], a[4:7], v[192:195]
    v_exp_f32 v201, v201
    v_fma_f32 v203, v203, s32, v221
    v_mfma_f32_16x16x32_bf16 v[192:195], a[136:139], a[8:11], v[192:195]
    v_cvt_pk_bf16_f32 v200, v200, v201
    v_exp_f32 v202, v202
    v_fma_f32 v204, v204, s32, v221
    v_mfma_f32_16x16x32_bf16 v[192:195], a[140:143], a[12:15], v[192:195]
    v_exp_f32 v203, v203
    v_exp_f32 v204, v204
    v_mfma_f32_16x16x32_bf16 v[196:199], a[144:147], a[0:3], 0
    v_cvt_pk_bf16_f32 v201, v202, v203
    v_fma_f32 v205, v205, s32, v221
    v_exp_f32 v205, v205
    v_mfma_f32_16x16x32_bf16 v[196:199], a[148:151], a[4:7], v[196:199]
    v_fma_f32 v206, v206, s32, v221
    v_exp_f32 v206, v206
    v_fma_f32 v207, v207, s32, v221
    v_exp_f32 v207, v207
    v_mfma_f32_16x16x32_bf16 v[196:199], a[152:155], a[8:11], v[196:199]
    v_cvt_pk_bf16_f32 v202, v204, v205
    v_cvt_pk_bf16_f32 v203, v206, v207
    v_mfma_f32_16x16x32_bf16 v[196:199], a[156:159], a[12:15], v[196:199]
    v_fma_f32 v192, v192, s32, v216
    v_fma_f32 v193, v193, s32, v216
    v_mfma_f32_16x16x32_bf16 v[160:163], a[160:163], v[200:203], 0
    v_exp_f32 v192, v192
    v_mfma_f32_16x16x32_bf16 v[164:167], a[164:167], v[200:203], 0
    v_exp_f32 v193, v193
    v_mfma_f32_16x16x32_bf16 v[168:171], a[168:171], v[200:203], 0
    v_cvt_pk_bf16_f32 v192, v192, v193
    v_fma_f32 v194, v194, s32, v216
    v_mfma_f32_16x16x32_bf16 v[172:175], a[172:175], v[200:203], 0
    v_exp_f32 v194, v194
    v_mfma_f32_16x16x32_bf16 v[176:179], a[176:179], v[200:203], 0
    v_fma_f32 v195, v195, s32, v216
    v_xor_b32 v223, 0x4000, v223
    v_mfma_f32_16x16x32_bf16 v[180:183], a[180:183], v[200:203], 0
    v_exp_f32 v195, v195
    v_mfma_f32_16x16x32_bf16 v[184:187], a[184:187], v[200:203], 0
    v_cvt_pk_bf16_f32 v193, v194, v195
    v_fma_f32 v196, v196, s32, v216
    v_mfma_f32_16x16x32_bf16 v[188:191], a[188:191], v[200:203], 0
    v_exp_f32 v196, v196
    v_mfma_f32_16x16x32_bf16 a[244:247], a[248:251], v[200:203], 0
    v_fma_f32 v197, v197, s32, v216
    v_xor_b32 v224, 0x4000, v224
    v_mfma_f32_16x16x32_bf16 v[200:203], a[128:131], a[16:19], 0
    v_exp_f32 v197, v197
    v_mfma_f32_16x16x32_bf16 v[200:203], a[132:135], a[20:23], v[200:203]
    v_cvt_pk_bf16_f32 v194, v196, v197
    v_fma_f32 v198, v198, s32, v216
    v_mfma_f32_16x16x32_bf16 v[200:203], a[136:139], a[24:27], v[200:203]
    v_exp_f32 v198, v198
    v_mfma_f32_16x16x32_bf16 v[200:203], a[140:143], a[28:31], v[200:203]
    v_fma_f32 v199, v199, s32, v216
    v_exp_f32 v199, v199
    v_mfma_f32_16x16x32_bf16 v[204:207], a[144:147], a[16:19], 0
    v_cvt_pk_bf16_f32 v195, v198, v199
    v_mfma_f32_16x16x32_bf16 v[204:207], a[148:151], a[20:23], v[204:207]
    s_waitcnt vmcnt(26) lgkmcnt(0)
.p2align 6
L_loopC:
    v_mfma_f32_16x16x32_bf16 v[204:207], a[152:155], a[24:27], v[204:207]
    s_barrier
    v_mfma_f32_16x16x32_bf16 v[204:207], a[156:159], a[28:31], v[204:207]
    v_fma_f32 v200, v200, s32, v217
    v_fma_f32 v201, v201, s32, v217
    v_mfma_f32_16x16x32_bf16 v[0:3], a[192:195], v[192:195], v[0:3]
    v_exp_f32 v200, v200
    v_mfma_f32_16x16x32_bf16 v[4:7], a[196:199], v[192:195], v[4:7]
    ds_read_b128 v[228:231], v227 offset:0
    v_exp_f32 v201, v201
    v_mfma_f32_16x16x32_bf16 v[8:11], a[200:203], v[192:195], v[8:11]
    v_fma_f32 v202, v202, s32, v217
    v_cvt_pk_bf16_f32 v200, v200, v201
    v_mfma_f32_16x16x32_bf16 v[12:15], a[204:207], v[192:195], v[12:15]
    v_exp_f32 v202, v202
    v_mfma_f32_16x16x32_bf16 v[16:19], a[208:211], v[192:195], v[16:19]
    ds_read_b128 a[96:99], v222 offset:0
    v_fma_f32 v203, v203, s32, v217
    v_mfma_f32_16x16x32_bf16 v[20:23], a[212:215], v[192:195], v[20:23]
    v_exp_f32 v203, v203
    v_mfma_f32_16x16x32_bf16 v[24:27], a[216:219], v[192:195], v[24:27]
    v_fma_f32 v204, v204, s32, v217
    v_cvt_pk_bf16_f32 v201, v202, v203
    v_mfma_f32_16x16x32_bf16 v[28:31], a[220:223], v[192:195], v[28:31]
    v_exp_f32 v204, v204
    v_mfma_f32_16x16x32_bf16 a[224:227], a[248:251], v[192:195], a[224:227]
    ds_read_b128 a[100:103], v222 offset:256
    v_fma_f32 v205, v205, s32, v217
    v_mfma_f32_16x16x32_bf16 v[192:195], a[128:131], a[32:35], 0
    v_exp_f32 v205, v205
    v_mfma_f32_16x16x32_bf16 v[192:195], a[132:135], a[36:39], v[192:195]
    v_fma_f32 v206, v206, s32, v217
    v_cvt_pk_bf16_f32 v202, v204, v205
    v_mfma_f32_16x16x32_bf16 v[192:195], a[136:139], a[40:43], v[192:195]
    v_exp_f32 v206, v206
    v_mfma_f32_16x16x32_bf16 v[192:195], a[140:143], a[44:47], v[192:195]
    ds_read_b128 a[104:107], v222 offset:512
    v_fma_f32 v207, v207, s32, v217
    v_mfma_f32_16x16x32_bf16 v[196:199], a[144:147], a[32:35], 0
    s_xor_b32 m0, s35, 0x8000
    v_exp_f32 v207, v207
    v_mfma_f32_16x16x32_bf16 v[196:199], a[148:151], a[36:39], v[196:199]
    ds_read_b128 a[108:111], v222 offset:768
    v_cvt_pk_bf16_f32 v203, v206, v207
    v_mfma_f32_16x16x32_bf16 v[196:199], a[152:155], a[40:43], v[196:199]
    buffer_load_dwordx4 v250, s[12:15], s34 offen nt lds
    v_mfma_f32_16x16x32_bf16 v[196:199], a[156:159], a[44:47], v[196:199]
    v_fma_f32 v192, v192, s32, v218
    v_fma_f32 v193, v193, s32, v218
    v_mfma_f32_16x16x32_bf16 v[32:35], a[192:195], v[200:203], v[32:35]
    v_exp_f32 v192, v192
    v_mfma_f32_16x16x32_bf16 v[36:39], a[196:199], v[200:203], v[36:39]
    v_exp_f32 v193, v193
    v_mfma_f32_16x16x32_bf16 v[40:43], a[200:203], v[200:203], v[40:43]
    v_fma_f32 v194, v194, s32, v218
    v_cvt_pk_bf16_f32 v192, v192, v193
    v_mfma_f32_16x16x32_bf16 v[44:47], a[204:207], v[200:203], v[44:47]
    v_exp_f32 v194, v194
    v_mfma_f32_16x16x32_bf16 v[48:51], a[208:211], v[200:203], v[48:51]
    ds_read_b128 a[112:115], v222 offset:1024
    v_fma_f32 v195, v195, s32, v218
    v_mfma_f32_16x16x32_bf16 v[52:55], a[212:215], v[200:203], v[52:55]
    v_exp_f32 v195, v195
    v_mfma_f32_16x16x32_bf16 v[56:59], a[216:219], v[200:203], v[56:59]
    v_fma_f32 v196, v196, s32, v218
    v_cvt_pk_bf16_f32 v193, v194, v195
    v_mfma_f32_16x16x32_bf16 v[60:63], a[220:223], v[200:203], v[60:63]
    v_exp_f32 v196, v196
    v_mfma_f32_16x16x32_bf16 a[228:231], a[248:251], v[200:203], a[228:231]
    ds_read_b128 a[116:119], v222 offset:1280
    v_fma_f32 v197, v197, s32, v218
    v_mfma_f32_16x16x32_bf16 v[200:203], a[128:131], a[48:51], 0
    v_exp_f32 v197, v197
    v_mfma_f32_16x16x32_bf16 v[200:203], a[132:135], a[52:55], v[200:203]
    v_fma_f32 v198, v198, s32, v218
    v_cvt_pk_bf16_f32 v194, v196, v197
    v_mfma_f32_16x16x32_bf16 v[200:203], a[136:139], a[56:59], v[200:203]
    v_exp_f32 v198, v198
    v_mfma_f32_16x16x32_bf16 v[200:203], a[140:143], a[60:63], v[200:203]
    ds_read_b128 a[120:123], v222 offset:1536
    v_fma_f32 v199, v199, s32, v218
    v_mfma_f32_16x16x32_bf16 v[204:207], a[144:147], a[48:51], 0
    v_exp_f32 v199, v199
    v_mfma_f32_16x16x32_bf16 v[204:207], a[148:151], a[52:55], v[204:207]
    ds_read_b128 a[124:127], v222 offset:1792
    v_cvt_pk_bf16_f32 v195, v198, v199
    v_mfma_f32_16x16x32_bf16 v[204:207], a[152:155], a[56:59], v[204:207]
    buffer_load_dwordx4 v250, s[12:15], s34 offen offset:1024 nt lds
    v_mfma_f32_16x16x32_bf16 v[204:207], a[156:159], a[60:63], v[204:207]
    v_fma_f32 v200, v200, s32, v219
    v_fma_f32 v201, v201, s32, v219
    v_mfma_f32_16x16x32_bf16 v[64:67], a[192:195], v[192:195], v[64:67]
    v_exp_f32 v200, v200
    v_mfma_f32_16x16x32_bf16 v[68:71], a[196:199], v[192:195], v[68:71]
    v_exp_f32 v201, v201
    v_mfma_f32_16x16x32_bf16 v[72:75], a[200:203], v[192:195], v[72:75]
    v_fma_f32 v202, v202, s32, v219
    v_cvt_pk_bf16_f32 v200, v200, v201
    v_mfma_f32_16x16x32_bf16 v[76:79], a[204:207], v[192:195], v[76:79]
    v_exp_f32 v202, v202
    v_mfma_f32_16x16x32_bf16 v[80:83], a[208:211], v[192:195], v[80:83]
    ds_read_b64_tr_b16 a[160:161], v223 offset:0
    v_fma_f32 v203, v203, s32, v219
    v_mfma_f32_16x16x32_bf16 v[84:87], a[212:215], v[192:195], v[84:87]
    v_exp_f32 v203, v203
    v_mfma_f32_16x16x32_bf16 v[88:91], a[216:219], v[192:195], v[88:91]
    v_fma_f32 v204, v204, s32, v219
    v_cvt_pk_bf16_f32 v201, v202, v203
    v_mfma_f32_16x16x32_bf16 v[92:95], a[220:223], v[192:195], v[92:95]
    v_exp_f32 v204, v204
    v_mfma_f32_16x16x32_bf16 a[232:235], a[248:251], v[192:195], a[232:235]
    ds_read_b64_tr_b16 a[162:163], v223 offset:1024
    v_fma_f32 v205, v205, s32, v219
    v_mfma_f32_16x16x32_bf16 v[192:195], a[128:131], a[64:67], 0
    v_exp_f32 v205, v205
    v_mfma_f32_16x16x32_bf16 v[192:195], a[132:135], a[68:71], v[192:195]
    v_fma_f32 v206, v206, s32, v219
    v_cvt_pk_bf16_f32 v202, v204, v205
    v_mfma_f32_16x16x32_bf16 v[192:195], a[136:139], a[72:75], v[192:195]
    v_exp_f32 v206, v206
    v_mfma_f32_16x16x32_bf16 v[192:195], a[140:143], a[76:79], v[192:195]
    ds_read_b64_tr_b16 a[164:165], v224 offset:0
    v_fma_f32 v207, v207, s32, v219
    v_mfma_f32_16x16x32_bf16 v[196:199], a[144:147], a[64:67], 0
    s_waitcnt lgkmcnt(3)
    v_exp_f32 v207, v207
    v_mfma_f32_16x16x32_bf16 v[196:199], a[148:151], a[68:71], v[196:199]
    s_mov_b32 m0, s35
    ds_read_b64_tr_b16 a[166:167], v224 offset:1024
    v_cvt_pk_bf16_f32 v203, v206, v207
    v_mfma_f32_16x16x32_bf16 v[196:199], a[152:155], a[72:75], v[196:199]
    buffer_load_dwordx4 v249, s[8:11], s34 offen nt lds
    v_mfma_f32_16x16x32_bf16 v[196:199], a[156:159], a[76:79], v[196:199]
    v_fma_f32 v192, v192, s32, v220
    v_fma_f32 v193, v193, s32, v220
    v_mfma_f32_16x16x32_bf16 v[96:99], a[192:195], v[200:203], v[96:99]
    v_exp_f32 v192, v192
    v_mfma_f32_16x16x32_bf16 v[100:103], a[196:199], v[200:203], v[100:103]
    v_exp_f32 v193, v193
    v_mfma_f32_16x16x32_bf16 v[104:107], a[200:203], v[200:203], v[104:107]
    v_fma_f32 v194, v194, s32, v220
    v_cvt_pk_bf16_f32 v192, v192, v193
    v_mfma_f32_16x16x32_bf16 v[108:111], a[204:207], v[200:203], v[108:111]
    v_exp_f32 v194, v194
    v_mfma_f32_16x16x32_bf16 v[112:115], a[208:211], v[200:203], v[112:115]
    ds_read_b64_tr_b16 a[168:169], v223 offset:256
    v_fma_f32 v195, v195, s32, v220
    v_mfma_f32_16x16x32_bf16 v[116:119], a[212:215], v[200:203], v[116:119]
    v_exp_f32 v195, v195
    v_mfma_f32_16x16x32_bf16 v[120:123], a[216:219], v[200:203], v[120:123]
    v_fma_f32 v196, v196, s32, v220
    v_cvt_pk_bf16_f32 v193, v194, v195
    v_mfma_f32_16x16x32_bf16 v[124:127], a[220:223], v[200:203], v[124:127]
    v_exp_f32 v196, v196
    v_mfma_f32_16x16x32_bf16 a[236:239], a[248:251], v[200:203], a[236:239]
    ds_read_b64_tr_b16 a[170:171], v223 offset:1280
    v_fma_f32 v197, v197, s32, v220
    v_mfma_f32_16x16x32_bf16 v[200:203], a[128:131], a[80:83], 0
    v_exp_f32 v197, v197
    v_mfma_f32_16x16x32_bf16 v[200:203], a[132:135], a[84:87], v[200:203]
    v_fma_f32 v198, v198, s32, v220
    v_cvt_pk_bf16_f32 v194, v196, v197
    v_mfma_f32_16x16x32_bf16 v[200:203], a[136:139], a[88:91], v[200:203]
    v_exp_f32 v198, v198
    v_mfma_f32_16x16x32_bf16 v[200:203], a[140:143], a[92:95], v[200:203]
    ds_read_b64_tr_b16 a[172:173], v224 offset:256
    v_fma_f32 v199, v199, s32, v220
    v_mfma_f32_16x16x32_bf16 v[204:207], a[144:147], a[80:83], 0
    v_exp_f32 v199, v199
    v_mfma_f32_16x16x32_bf16 v[204:207], a[148:151], a[84:87], v[204:207]
    ds_read_b64_tr_b16 a[174:175], v224 offset:1280
    v_cvt_pk_bf16_f32 v195, v198, v199
    v_mfma_f32_16x16x32_bf16 v[204:207], a[152:155], a[88:91], v[204:207]
    buffer_load_dwordx4 v249, s[8:11], s34 offen offset:1024 nt lds
    v_mfma_f32_16x16x32_bf16 v[204:207], a[156:159], a[92:95], v[204:207]
    ds_read_b64_tr_b16 a[176:177], v223 offset:512
    v_fma_f32 v200, v200, s32, v221
    v_mfma_f32_16x16x32_bf16 v[128:131], a[192:195], v[192:195], v[128:131]
    s_add_u32 s34, s34, 0x2000
    v_exp_f32 v200, v200
    v_mfma_f32_16x16x32_bf16 v[132:135], a[196:199], v[192:195], v[132:135]
    ds_read_b64_tr_b16 a[178:179], v223 offset:1536
    v_fma_f32 v201, v201, s32, v221
    v_mfma_f32_16x16x32_bf16 v[136:139], a[200:203], v[192:195], v[136:139]
    s_xor_b32 s35, s35, 0x6000
    v_exp_f32 v201, v201
    v_mfma_f32_16x16x32_bf16 v[140:143], a[204:207], v[192:195], v[140:143]
    v_fma_f32 v202, v202, s32, v221
    v_cvt_pk_bf16_f32 v200, v200, v201
    v_mfma_f32_16x16x32_bf16 v[144:147], a[208:211], v[192:195], v[144:147]
    buffer_store_dwordx4 v[228:231], v244, s[20:23], s40 offen nt
    v_exp_f32 v202, v202
    v_mfma_f32_16x16x32_bf16 v[148:151], a[212:215], v[192:195], v[148:151]
    ds_read_b64_tr_b16 a[180:181], v224 offset:512
    v_fma_f32 v203, v203, s32, v221
    v_mfma_f32_16x16x32_bf16 v[152:155], a[216:219], v[192:195], v[152:155]
    v_exp_f32 v203, v203
    v_mfma_f32_16x16x32_bf16 v[156:159], a[220:223], v[192:195], v[156:159]
    v_fma_f32 v204, v204, s32, v221
    v_cvt_pk_bf16_f32 v201, v202, v203
    v_mfma_f32_16x16x32_bf16 a[240:243], a[248:251], v[192:195], a[240:243]
    v_exp_f32 v204, v204
    v_mfma_f32_16x16x32_bf16 v[192:195], a[96:99], a[0:3], 0
    ds_read_b64_tr_b16 a[182:183], v224 offset:1536
    v_fma_f32 v205, v205, s32, v221
    v_mfma_f32_16x16x32_bf16 v[192:195], a[100:103], a[4:7], v[192:195]
    v_exp_f32 v205, v205
    v_mfma_f32_16x16x32_bf16 v[192:195], a[104:107], a[8:11], v[192:195]
    v_fma_f32 v206, v206, s32, v221
    v_cvt_pk_bf16_f32 v202, v204, v205
    v_mfma_f32_16x16x32_bf16 v[192:195], a[108:111], a[12:15], v[192:195]
    v_exp_f32 v206, v206
    v_mfma_f32_16x16x32_bf16 v[196:199], a[112:115], a[0:3], 0
    ds_read_b64_tr_b16 a[184:185], v223 offset:768
    v_fma_f32 v207, v207, s32, v221
    v_mfma_f32_16x16x32_bf16 v[196:199], a[116:119], a[4:7], v[196:199]
    v_exp_f32 v207, v207
    v_mfma_f32_16x16x32_bf16 v[196:199], a[120:123], a[8:11], v[196:199]
    ds_read_b64_tr_b16 a[186:187], v223 offset:1792
    v_cvt_pk_bf16_f32 v203, v206, v207
    v_mfma_f32_16x16x32_bf16 v[196:199], a[124:127], a[12:15], v[196:199]
    ds_read_b64_tr_b16 a[188:189], v224 offset:768
    v_fma_f32 v192, v192, s32, v216
    v_mfma_f32_16x16x32_bf16 v[160:163], a[192:195], v[200:203], v[160:163]
    v_exp_f32 v192, v192
    v_mfma_f32_16x16x32_bf16 v[164:167], a[196:199], v[200:203], v[164:167]
    ds_read_b64_tr_b16 a[190:191], v224 offset:1792
    v_fma_f32 v193, v193, s32, v216
    v_mfma_f32_16x16x32_bf16 v[168:171], a[200:203], v[200:203], v[168:171]
    v_exp_f32 v193, v193
    v_mfma_f32_16x16x32_bf16 v[172:175], a[204:207], v[200:203], v[172:175]
    v_fma_f32 v194, v194, s32, v216
    v_cvt_pk_bf16_f32 v192, v192, v193
    v_mfma_f32_16x16x32_bf16 v[176:179], a[208:211], v[200:203], v[176:179]
    v_exp_f32 v194, v194
    v_mfma_f32_16x16x32_bf16 v[180:183], a[212:215], v[200:203], v[180:183]
    v_fma_f32 v195, v195, s32, v216
    v_fma_f32 v196, v196, s32, v216
    v_mfma_f32_16x16x32_bf16 v[184:187], a[216:219], v[200:203], v[184:187]
    v_exp_f32 v195, v195
    v_mfma_f32_16x16x32_bf16 v[188:191], a[220:223], v[200:203], v[188:191]
    v_exp_f32 v196, v196
    v_mfma_f32_16x16x32_bf16 a[244:247], a[248:251], v[200:203], a[244:247]
    v_fma_f32 v197, v197, s32, v216
    v_cvt_pk_bf16_f32 v193, v194, v195
    v_mfma_f32_16x16x32_bf16 v[200:203], a[96:99], a[16:19], 0
    v_exp_f32 v197, v197
    v_mfma_f32_16x16x32_bf16 v[200:203], a[100:103], a[20:23], v[200:203]
    v_fma_f32 v198, v198, s32, v216
    v_fma_f32 v199, v199, s32, v216
    v_mfma_f32_16x16x32_bf16 v[200:203], a[104:107], a[24:27], v[200:203]
    v_exp_f32 v198, v198
    v_mfma_f32_16x16x32_bf16 v[200:203], a[108:111], a[28:31], v[200:203]
    v_exp_f32 v199, v199
    v_mfma_f32_16x16x32_bf16 v[204:207], a[112:115], a[16:19], 0
    v_cvt_pk_bf16_f32 v194, v196, v197
    v_cvt_pk_bf16_f32 v195, v198, v199
    v_mfma_f32_16x16x32_bf16 v[204:207], a[116:119], a[20:23], v[204:207]
    s_waitcnt vmcnt(11) lgkmcnt(0)
    v_mfma_f32_16x16x32_bf16 v[204:207], a[120:123], a[24:27], v[204:207]
    s_barrier
    v_mfma_f32_16x16x32_bf16 v[204:207], a[124:127], a[28:31], v[204:207]
    v_fma_f32 v200, v200, s32, v217
    v_fma_f32 v201, v201, s32, v217
    v_mfma_f32_16x16x32_bf16 v[0:3], a[160:163], v[192:195], v[0:3]
    v_exp_f32 v200, v200
    v_mfma_f32_16x16x32_bf16 v[4:7], a[164:167], v[192:195], v[4:7]
    ds_read_b128 v[228:231], v227 offset:1024
    v_exp_f32 v201, v201
    v_mfma_f32_16x16x32_bf16 v[8:11], a[168:171], v[192:195], v[8:11]
    v_fma_f32 v202, v202, s32, v217
    v_cvt_pk_bf16_f32 v200, v200, v201
    v_mfma_f32_16x16x32_bf16 v[12:15], a[172:175], v[192:195], v[12:15]
    v_exp_f32 v202, v202
    v_mfma_f32_16x16x32_bf16 v[16:19], a[176:179], v[192:195], v[16:19]
    ds_read_b128 a[128:131], v222 offset:8192
    v_fma_f32 v203, v203, s32, v217
    v_mfma_f32_16x16x32_bf16 v[20:23], a[180:183], v[192:195], v[20:23]
    v_exp_f32 v203, v203
    v_mfma_f32_16x16x32_bf16 v[24:27], a[184:187], v[192:195], v[24:27]
    v_fma_f32 v204, v204, s32, v217
    v_cvt_pk_bf16_f32 v201, v202, v203
    v_add_u32 v227, 0x800, v227
    v_mfma_f32_16x16x32_bf16 v[28:31], a[188:191], v[192:195], v[28:31]
    v_exp_f32 v204, v204
    v_mfma_f32_16x16x32_bf16 a[224:227], a[248:251], v[192:195], a[224:227]
    ds_read_b128 a[132:135], v222 offset:8448
    v_fma_f32 v205, v205, s32, v217
    v_mfma_f32_16x16x32_bf16 v[192:195], a[96:99], a[32:35], 0
    v_exp_f32 v205, v205
    v_mfma_f32_16x16x32_bf16 v[192:195], a[100:103], a[36:39], v[192:195]
    v_fma_f32 v206, v206, s32, v217
    v_cvt_pk_bf16_f32 v202, v204, v205
    v_mfma_f32_16x16x32_bf16 v[192:195], a[104:107], a[40:43], v[192:195]
    v_exp_f32 v206, v206
    v_mfma_f32_16x16x32_bf16 v[192:195], a[108:111], a[44:47], v[192:195]
    ds_read_b128 a[136:139], v222 offset:8704
    v_fma_f32 v207, v207, s32, v217
    v_mfma_f32_16x16x32_bf16 v[196:199], a[112:115], a[32:35], 0
    s_xor_b32 m0, s35, 0x8000
    v_exp_f32 v207, v207
    v_mfma_f32_16x16x32_bf16 v[196:199], a[116:119], a[36:39], v[196:199]
    ds_read_b128 a[140:143], v222 offset:8960
    v_cvt_pk_bf16_f32 v203, v206, v207
    v_mfma_f32_16x16x32_bf16 v[196:199], a[120:123], a[40:43], v[196:199]
    buffer_load_dwordx4 v250, s[12:15], s34 offen nt lds
    v_mfma_f32_16x16x32_bf16 v[196:199], a[124:127], a[44:47], v[196:199]
    v_fma_f32 v192, v192, s32, v218
    v_fma_f32 v193, v193, s32, v218
    v_mfma_f32_16x16x32_bf16 v[32:35], a[160:163], v[200:203], v[32:35]
    v_exp_f32 v192, v192
    v_mfma_f32_16x16x32_bf16 v[36:39], a[164:167], v[200:203], v[36:39]
    v_exp_f32 v193, v193
    v_mfma_f32_16x16x32_bf16 v[40:43], a[168:171], v[200:203], v[40:43]
    v_fma_f32 v194, v194, s32, v218
    v_cvt_pk_bf16_f32 v192, v192, v193
    v_mfma_f32_16x16x32_bf16 v[44:47], a[172:175], v[200:203], v[44:47]
    v_exp_f32 v194, v194
    v_mfma_f32_16x16x32_bf16 v[48:51], a[176:179], v[200:203], v[48:51]
    ds_read_b128 a[144:147], v222 offset:9216
    v_fma_f32 v195, v195, s32, v218
    v_mfma_f32_16x16x32_bf16 v[52:55], a[180:183], v[200:203], v[52:55]
    v_exp_f32 v195, v195
    v_mfma_f32_16x16x32_bf16 v[56:59], a[184:187], v[200:203], v[56:59]
    v_fma_f32 v196, v196, s32, v218
    v_cvt_pk_bf16_f32 v193, v194, v195
    v_mfma_f32_16x16x32_bf16 v[60:63], a[188:191], v[200:203], v[60:63]
    v_exp_f32 v196, v196
    v_mfma_f32_16x16x32_bf16 a[228:231], a[248:251], v[200:203], a[228:231]
    ds_read_b128 a[148:151], v222 offset:9472
    v_fma_f32 v197, v197, s32, v218
    v_mfma_f32_16x16x32_bf16 v[200:203], a[96:99], a[48:51], 0
    v_exp_f32 v197, v197
    v_mfma_f32_16x16x32_bf16 v[200:203], a[100:103], a[52:55], v[200:203]
    v_fma_f32 v198, v198, s32, v218
    v_cvt_pk_bf16_f32 v194, v196, v197
    v_mfma_f32_16x16x32_bf16 v[200:203], a[104:107], a[56:59], v[200:203]
    v_exp_f32 v198, v198
    v_mfma_f32_16x16x32_bf16 v[200:203], a[108:111], a[60:63], v[200:203]
    ds_read_b128 a[152:155], v222 offset:9728
    v_fma_f32 v199, v199, s32, v218
    v_mfma_f32_16x16x32_bf16 v[204:207], a[112:115], a[48:51], 0
    v_exp_f32 v199, v199
    v_mfma_f32_16x16x32_bf16 v[204:207], a[116:119], a[52:55], v[204:207]
    ds_read_b128 a[156:159], v222 offset:9984
    v_cvt_pk_bf16_f32 v195, v198, v199
    v_mfma_f32_16x16x32_bf16 v[204:207], a[120:123], a[56:59], v[204:207]
    buffer_load_dwordx4 v250, s[12:15], s34 offen offset:1024 nt lds
    v_mfma_f32_16x16x32_bf16 v[204:207], a[124:127], a[60:63], v[204:207]
    v_fma_f32 v200, v200, s32, v219
    v_fma_f32 v201, v201, s32, v219
    v_mfma_f32_16x16x32_bf16 v[64:67], a[160:163], v[192:195], v[64:67]
    v_exp_f32 v200, v200
    v_mfma_f32_16x16x32_bf16 v[68:71], a[164:167], v[192:195], v[68:71]
    v_exp_f32 v201, v201
    v_xor_b32 v222, 0x4000, v222
    v_mfma_f32_16x16x32_bf16 v[72:75], a[168:171], v[192:195], v[72:75]
    v_fma_f32 v202, v202, s32, v219
    v_cvt_pk_bf16_f32 v200, v200, v201
    v_mfma_f32_16x16x32_bf16 v[76:79], a[172:175], v[192:195], v[76:79]
    v_exp_f32 v202, v202
    v_mfma_f32_16x16x32_bf16 v[80:83], a[176:179], v[192:195], v[80:83]
    ds_read_b64_tr_b16 a[192:193], v223 offset:8192
    v_fma_f32 v203, v203, s32, v219
    v_mfma_f32_16x16x32_bf16 v[84:87], a[180:183], v[192:195], v[84:87]
    v_exp_f32 v203, v203
    v_mfma_f32_16x16x32_bf16 v[88:91], a[184:187], v[192:195], v[88:91]
    v_fma_f32 v204, v204, s32, v219
    v_cvt_pk_bf16_f32 v201, v202, v203
    v_mfma_f32_16x16x32_bf16 v[92:95], a[188:191], v[192:195], v[92:95]
    v_exp_f32 v204, v204
    v_mfma_f32_16x16x32_bf16 a[232:235], a[248:251], v[192:195], a[232:235]
    ds_read_b64_tr_b16 a[194:195], v223 offset:9216
    v_fma_f32 v205, v205, s32, v219
    v_mfma_f32_16x16x32_bf16 v[192:195], a[96:99], a[64:67], 0
    v_exp_f32 v205, v205
    v_mfma_f32_16x16x32_bf16 v[192:195], a[100:103], a[68:71], v[192:195]
    v_fma_f32 v206, v206, s32, v219
    v_cvt_pk_bf16_f32 v202, v204, v205
    v_mfma_f32_16x16x32_bf16 v[192:195], a[104:107], a[72:75], v[192:195]
    v_exp_f32 v206, v206
    v_mfma_f32_16x16x32_bf16 v[192:195], a[108:111], a[76:79], v[192:195]
    ds_read_b64_tr_b16 a[196:197], v224 offset:8192
    v_fma_f32 v207, v207, s32, v219
    v_mfma_f32_16x16x32_bf16 v[196:199], a[112:115], a[64:67], 0
    s_waitcnt lgkmcnt(3)
    v_exp_f32 v207, v207
    v_mfma_f32_16x16x32_bf16 v[196:199], a[116:119], a[68:71], v[196:199]
    s_mov_b32 m0, s35
    ds_read_b64_tr_b16 a[198:199], v224 offset:9216
    v_cvt_pk_bf16_f32 v203, v206, v207
    v_mfma_f32_16x16x32_bf16 v[196:199], a[120:123], a[72:75], v[196:199]
    buffer_load_dwordx4 v249, s[8:11], s34 offen nt lds
    v_mfma_f32_16x16x32_bf16 v[196:199], a[124:127], a[76:79], v[196:199]
    v_fma_f32 v192, v192, s32, v220
    v_fma_f32 v193, v193, s32, v220
    v_mfma_f32_16x16x32_bf16 v[96:99], a[160:163], v[200:203], v[96:99]
    v_exp_f32 v192, v192
    v_mfma_f32_16x16x32_bf16 v[100:103], a[164:167], v[200:203], v[100:103]
    v_exp_f32 v193, v193
    v_mfma_f32_16x16x32_bf16 v[104:107], a[168:171], v[200:203], v[104:107]
    v_fma_f32 v194, v194, s32, v220
    v_cvt_pk_bf16_f32 v192, v192, v193
    v_mfma_f32_16x16x32_bf16 v[108:111], a[172:175], v[200:203], v[108:111]
    v_exp_f32 v194, v194
    v_mfma_f32_16x16x32_bf16 v[112:115], a[176:179], v[200:203], v[112:115]
    ds_read_b64_tr_b16 a[200:201], v223 offset:8448
    v_fma_f32 v195, v195, s32, v220
    v_mfma_f32_16x16x32_bf16 v[116:119], a[180:183], v[200:203], v[116:119]
    v_exp_f32 v195, v195
    v_mfma_f32_16x16x32_bf16 v[120:123], a[184:187], v[200:203], v[120:123]
    v_fma_f32 v196, v196, s32, v220
    v_cvt_pk_bf16_f32 v193, v194, v195
    v_mfma_f32_16x16x32_bf16 v[124:127], a[188:191], v[200:203], v[124:127]
    v_exp_f32 v196, v196
    v_mfma_f32_16x16x32_bf16 a[236:239], a[248:251], v[200:203], a[236:239]
    ds_read_b64_tr_b16 a[202:203], v223 offset:9472
    v_fma_f32 v197, v197, s32, v220
    v_mfma_f32_16x16x32_bf16 v[200:203], a[96:99], a[80:83], 0
    v_exp_f32 v197, v197
    v_mfma_f32_16x16x32_bf16 v[200:203], a[100:103], a[84:87], v[200:203]
    v_fma_f32 v198, v198, s32, v220
    v_cvt_pk_bf16_f32 v194, v196, v197
    v_mfma_f32_16x16x32_bf16 v[200:203], a[104:107], a[88:91], v[200:203]
    v_exp_f32 v198, v198
    v_mfma_f32_16x16x32_bf16 v[200:203], a[108:111], a[92:95], v[200:203]
    ds_read_b64_tr_b16 a[204:205], v224 offset:8448
    v_fma_f32 v199, v199, s32, v220
    v_mfma_f32_16x16x32_bf16 v[204:207], a[112:115], a[80:83], 0
    v_exp_f32 v199, v199
    v_mfma_f32_16x16x32_bf16 v[204:207], a[116:119], a[84:87], v[204:207]
    ds_read_b64_tr_b16 a[206:207], v224 offset:9472
    v_cvt_pk_bf16_f32 v195, v198, v199
    v_mfma_f32_16x16x32_bf16 v[204:207], a[120:123], a[88:91], v[204:207]
    buffer_load_dwordx4 v249, s[8:11], s34 offen offset:1024 nt lds
    v_mfma_f32_16x16x32_bf16 v[204:207], a[124:127], a[92:95], v[204:207]
    ds_read_b64_tr_b16 a[208:209], v223 offset:8704
    v_fma_f32 v200, v200, s32, v221
    v_mfma_f32_16x16x32_bf16 v[128:131], a[160:163], v[192:195], v[128:131]
    s_add_u32 s34, s34, 0x2000
    v_exp_f32 v200, v200
    v_mfma_f32_16x16x32_bf16 v[132:135], a[164:167], v[192:195], v[132:135]
    ds_read_b64_tr_b16 a[210:211], v223 offset:9728
    v_fma_f32 v201, v201, s32, v221
    v_mfma_f32_16x16x32_bf16 v[136:139], a[168:171], v[192:195], v[136:139]
    s_xor_b32 s35, s35, 0x2000
    v_exp_f32 v201, v201
    v_mfma_f32_16x16x32_bf16 v[140:143], a[172:175], v[192:195], v[140:143]
    v_fma_f32 v202, v202, s32, v221
    v_cvt_pk_bf16_f32 v200, v200, v201
    v_mfma_f32_16x16x32_bf16 v[144:147], a[176:179], v[192:195], v[144:147]
    buffer_store_dwordx4 v[228:231], v245, s[20:23], s40 offen offset:1024 nt
    v_exp_f32 v202, v202
    v_mfma_f32_16x16x32_bf16 v[148:151], a[180:183], v[192:195], v[148:151]
    ds_read_b64_tr_b16 a[212:213], v224 offset:8704
    v_fma_f32 v203, v203, s32, v221
    v_mfma_f32_16x16x32_bf16 v[152:155], a[184:187], v[192:195], v[152:155]
    v_exp_f32 v203, v203
    v_mfma_f32_16x16x32_bf16 v[156:159], a[188:191], v[192:195], v[156:159]
    v_fma_f32 v204, v204, s32, v221
    v_cvt_pk_bf16_f32 v201, v202, v203
    v_mfma_f32_16x16x32_bf16 a[240:243], a[248:251], v[192:195], a[240:243]
    v_exp_f32 v204, v204
    v_mfma_f32_16x16x32_bf16 v[192:195], a[128:131], a[0:3], 0
    ds_read_b64_tr_b16 a[214:215], v224 offset:9728
    v_fma_f32 v205, v205, s32, v221
    v_mfma_f32_16x16x32_bf16 v[192:195], a[132:135], a[4:7], v[192:195]
    s_add_u32 s40, s40, 0x800
    v_exp_f32 v205, v205
    v_mfma_f32_16x16x32_bf16 v[192:195], a[136:139], a[8:11], v[192:195]
    v_fma_f32 v206, v206, s32, v221
    v_cvt_pk_bf16_f32 v202, v204, v205
    v_mfma_f32_16x16x32_bf16 v[192:195], a[140:143], a[12:15], v[192:195]
    v_exp_f32 v206, v206
    v_mfma_f32_16x16x32_bf16 v[196:199], a[144:147], a[0:3], 0
    ds_read_b64_tr_b16 a[216:217], v223 offset:8960
    v_fma_f32 v207, v207, s32, v221
    v_mfma_f32_16x16x32_bf16 v[196:199], a[148:151], a[4:7], v[196:199]
    v_exp_f32 v207, v207
    v_mfma_f32_16x16x32_bf16 v[196:199], a[152:155], a[8:11], v[196:199]
    ds_read_b64_tr_b16 a[218:219], v223 offset:9984
    v_cvt_pk_bf16_f32 v203, v206, v207
    v_mfma_f32_16x16x32_bf16 v[196:199], a[156:159], a[12:15], v[196:199]
    ds_read_b64_tr_b16 a[220:221], v224 offset:8960
    v_fma_f32 v192, v192, s32, v216
    v_mfma_f32_16x16x32_bf16 v[160:163], a[160:163], v[200:203], v[160:163]
    v_exp_f32 v192, v192
    v_mfma_f32_16x16x32_bf16 v[164:167], a[164:167], v[200:203], v[164:167]
    ds_read_b64_tr_b16 a[222:223], v224 offset:9984
    v_fma_f32 v193, v193, s32, v216
    v_mfma_f32_16x16x32_bf16 v[168:171], a[168:171], v[200:203], v[168:171]
    v_exp_f32 v193, v193
    v_mfma_f32_16x16x32_bf16 v[172:175], a[172:175], v[200:203], v[172:175]
    v_fma_f32 v194, v194, s32, v216
    v_cvt_pk_bf16_f32 v192, v192, v193
    v_xor_b32 v223, 0x4000, v223
    v_mfma_f32_16x16x32_bf16 v[176:179], a[176:179], v[200:203], v[176:179]
    v_exp_f32 v194, v194
    v_mfma_f32_16x16x32_bf16 v[180:183], a[180:183], v[200:203], v[180:183]
    v_fma_f32 v195, v195, s32, v216
    v_fma_f32 v196, v196, s32, v216
    v_xor_b32 v224, 0x4000, v224
    v_mfma_f32_16x16x32_bf16 v[184:187], a[184:187], v[200:203], v[184:187]
    v_exp_f32 v195, v195
    v_mfma_f32_16x16x32_bf16 v[188:191], a[188:191], v[200:203], v[188:191]
    v_exp_f32 v196, v196
    v_mfma_f32_16x16x32_bf16 a[244:247], a[248:251], v[200:203], a[244:247]
    v_fma_f32 v197, v197, s32, v216
    v_cvt_pk_bf16_f32 v193, v194, v195
    v_mfma_f32_16x16x32_bf16 v[200:203], a[128:131], a[16:19], 0
    v_exp_f32 v197, v197
    v_mfma_f32_16x16x32_bf16 v[200:203], a[132:135], a[20:23], v[200:203]
    v_fma_f32 v198, v198, s32, v216
    v_fma_f32 v199, v199, s32, v216
    v_mfma_f32_16x16x32_bf16 v[200:203], a[136:139], a[24:27], v[200:203]
    s_sub_u32 s38, s38, 1
    v_exp_f32 v198, v198
    v_mfma_f32_16x16x32_bf16 v[200:203], a[140:143], a[28:31], v[200:203]
    s_cmp_lg_u32 s38, 0
    v_exp_f32 v199, v199
    v_mfma_f32_16x16x32_bf16 v[204:207], a[144:147], a[16:19], 0
    v_cvt_pk_bf16_f32 v194, v196, v197
    v_cvt_pk_bf16_f32 v195, v198, v199
    v_mfma_f32_16x16x32_bf16 v[204:207], a[148:151], a[20:23], v[204:207]
    s_waitcnt vmcnt(11) lgkmcnt(0)
    s_cbranch_scc1 L_loopC
    v_mfma_f32_16x16x32_bf16 v[204:207], a[152:155], a[24:27], v[204:207]
    s_barrier
    v_mfma_f32_16x16x32_bf16 v[204:207], a[156:159], a[28:31], v[204:207]
    ds_read_b128 v[228:231], v227 offset:0
    v_fma_f32 v200, v200, s32, v217
    v_mfma_f32_16x16x32_bf16 v[0:3], a[192:195], v[192:195], v[0:3]
    ds_read_b128 v[232:235], v227 offset:1024
    v_fma_f32 v201, v201, s32, v217
    v_mfma_f32_16x16x32_bf16 v[4:7], a[196:199], v[192:195], v[4:7]
    ds_read_b128 v[236:239], v227 offset:2048
    v_fma_f32 v202, v202, s32, v217
    v_mfma_f32_16x16x32_bf16 v[8:11], a[200:203], v[192:195], v[8:11]
    ds_read_b128 v[240:243], v227 offset:3072
    v_add_u32 v227, 0x1000, v227
    v_mfma_f32_16x16x32_bf16 v[12:15], a[204:207], v[192:195], v[12:15]
    v_exp_f32 v200, v200
    v_mfma_f32_16x16x32_bf16 v[16:19], a[208:211], v[192:195], v[16:19]
    v_exp_f32 v201, v201
    v_mfma_f32_16x16x32_bf16 v[20:23], a[212:215], v[192:195], v[20:23]
    ds_read_b128 a[96:99], v222 offset:0
    v_cvt_pk_bf16_f32 v200, v200, v201
    v_mfma_f32_16x16x32_bf16 v[24:27], a[216:219], v[192:195], v[24:27]
    s_waitcnt lgkmcnt(1)
    v_exp_f32 v202, v202
    v_mfma_f32_16x16x32_bf16 v[28:31], a[220:223], v[192:195], v[28:31]
    v_fma_f32 v203, v203, s32, v217
    v_fma_f32 v204, v204, s32, v217
    v_mfma_f32_16x16x32_bf16 a[224:227], a[248:251], v[192:195], a[224:227]
    buffer_store_dwordx4 v[228:231], v244, s[20:23], s40 offen nt
    v_mfma_f32_16x16x32_bf16 v[192:195], a[128:131], a[32:35], 0
    ds_read_b128 a[100:103], v222 offset:256
    v_exp_f32 v203, v203
    v_fma_f32 v205, v205, s32, v217
    v_mfma_f32_16x16x32_bf16 v[192:195], a[132:135], a[36:39], v[192:195]
    v_cvt_pk_bf16_f32 v201, v202, v203
    v_exp_f32 v204, v204
    v_fma_f32 v206, v206, s32, v217
    v_mfma_f32_16x16x32_bf16 v[192:195], a[136:139], a[40:43], v[192:195]
    buffer_store_dwordx4 v[232:235], v245, s[20:23], s40 offen offset:1024 nt
    v_mfma_f32_16x16x32_bf16 v[192:195], a[140:143], a[44:47], v[192:195]
    ds_read_b128 a[104:107], v222 offset:512
    v_exp_f32 v205, v205
    v_fma_f32 v207, v207, s32, v217
    v_mfma_f32_16x16x32_bf16 v[196:199], a[144:147], a[32:35], 0
    ds_read_b128 a[108:111], v222 offset:768
    v_cvt_pk_bf16_f32 v202, v204, v205
    v_exp_f32 v206, v206
    v_mfma_f32_16x16x32_bf16 v[196:199], a[148:151], a[36:39], v[196:199]
    buffer_store_dwordx4 v[236:239], v244, s[20:23], s40 offen offset:2048 nt
    v_exp_f32 v207, v207
    v_mfma_f32_16x16x32_bf16 v[196:199], a[152:155], a[40:43], v[196:199]
    ds_read_b128 a[112:115], v222 offset:1024
    v_cvt_pk_bf16_f32 v203, v206, v207
    v_mfma_f32_16x16x32_bf16 v[196:199], a[156:159], a[44:47], v[196:199]
    v_fma_f32 v192, v192, s32, v218
    v_fma_f32 v193, v193, s32, v218
    v_mfma_f32_16x16x32_bf16 v[32:35], a[192:195], v[200:203], v[32:35]
    buffer_store_dwordx4 v[240:243], v245, s[20:23], s40 offen offset:3072 nt
    v_mfma_f32_16x16x32_bf16 v[36:39], a[196:199], v[200:203], v[36:39]
    s_add_u32 s40, s40, 0x1000
    v_exp_f32 v192, v192
    v_mfma_f32_16x16x32_bf16 v[40:43], a[200:203], v[200:203], v[40:43]
    v_exp_f32 v193, v193
    v_mfma_f32_16x16x32_bf16 v[44:47], a[204:207], v[200:203], v[44:47]
    ds_read_b128 v[228:231], v227 offset:0
    v_cvt_pk_bf16_f32 v192, v192, v193
    v_mfma_f32_16x16x32_bf16 v[48:51], a[208:211], v[200:203], v[48:51]
    ds_read_b128 v[232:235], v227 offset:1024
    v_fma_f32 v194, v194, s32, v218
    v_mfma_f32_16x16x32_bf16 v[52:55], a[212:215], v[200:203], v[52:55]
    ds_read_b128 v[236:239], v227 offset:2048
    v_fma_f32 v195, v195, s32, v218
    v_mfma_f32_16x16x32_bf16 v[56:59], a[216:219], v[200:203], v[56:59]
    ds_read_b128 v[240:243], v227 offset:3072
    v_add_u32 v227, 0x1000, v227
    v_mfma_f32_16x16x32_bf16 v[60:63], a[220:223], v[200:203], v[60:63]
    v_exp_f32 v194, v194
    v_mfma_f32_16x16x32_bf16 a[228:231], a[248:251], v[200:203], a[228:231]
    v_exp_f32 v195, v195
    v_mfma_f32_16x16x32_bf16 v[200:203], a[128:131], a[48:51], 0
    ds_read_b128 a[116:119], v222 offset:1280
    v_cvt_pk_bf16_f32 v193, v194, v195
    v_mfma_f32_16x16x32_bf16 v[200:203], a[132:135], a[52:55], v[200:203]
    s_waitcnt lgkmcnt(1)
    v_fma_f32 v196, v196, s32, v218
    v_fma_f32 v197, v197, s32, v218
    v_mfma_f32_16x16x32_bf16 v[200:203], a[136:139], a[56:59], v[200:203]
    ds_read_b128 a[120:123], v222 offset:1536
    v_exp_f32 v196, v196
    v_mfma_f32_16x16x32_bf16 v[200:203], a[140:143], a[60:63], v[200:203]
    v_exp_f32 v197, v197
    v_fma_f32 v198, v198, s32, v218
    v_mfma_f32_16x16x32_bf16 v[204:207], a[144:147], a[48:51], 0
    buffer_store_dwordx4 v[228:231], v244, s[20:23], s40 offen nt
    v_mfma_f32_16x16x32_bf16 v[204:207], a[148:151], a[52:55], v[204:207]
    v_exp_f32 v198, v198
    v_fma_f32 v199, v199, s32, v218
    v_exp_f32 v199, v199
    v_mfma_f32_16x16x32_bf16 v[204:207], a[152:155], a[56:59], v[204:207]
    v_cvt_pk_bf16_f32 v194, v196, v197
    v_cvt_pk_bf16_f32 v195, v198, v199
    v_mfma_f32_16x16x32_bf16 v[204:207], a[156:159], a[60:63], v[204:207]
    buffer_store_dwordx4 v[232:235], v245, s[20:23], s40 offen offset:1024 nt
    v_mfma_f32_16x16x32_bf16 v[64:67], a[192:195], v[192:195], v[64:67]
    ds_read_b128 a[124:127], v222 offset:1792
    v_fma_f32 v200, v200, s32, v219
    v_mfma_f32_16x16x32_bf16 v[68:71], a[196:199], v[192:195], v[68:71]
    ds_read_b64_tr_b16 a[160:161], v223 offset:0
    ds_read_b64_tr_b16 a[162:163], v223 offset:1024
    v_mfma_f32_16x16x32_bf16 v[72:75], a[200:203], v[192:195], v[72:75]
    buffer_store_dwordx4 v[236:239], v244, s[20:23], s40 offen offset:2048 nt
    v_mfma_f32_16x16x32_bf16 v[76:79], a[204:207], v[192:195], v[76:79]
    ds_read_b64_tr_b16 a[164:165], v224 offset:0
    ds_read_b64_tr_b16 a[166:167], v224 offset:1024
    v_mfma_f32_16x16x32_bf16 v[80:83], a[208:211], v[192:195], v[80:83]
    ds_read_b64_tr_b16 a[168:169], v223 offset:256
    ds_read_b64_tr_b16 a[170:171], v223 offset:1280
    v_mfma_f32_16x16x32_bf16 v[84:87], a[212:215], v[192:195], v[84:87]
    buffer_store_dwordx4 v[240:243], v245, s[20:23], s40 offen offset:3072 nt
    v_mfma_f32_16x16x32_bf16 v[88:91], a[216:219], v[192:195], v[88:91]
    s_add_u32 s40, s40, 0x1000
    v_exp_f32 v200, v200
    v_mfma_f32_16x16x32_bf16 v[92:95], a[220:223], v[192:195], v[92:95]
    s_mov_b32 s40, 0x18000
    v_fma_f32 v201, v201, s32, v219
    v_exp_f32 v201, v201
    v_mfma_f32_16x16x32_bf16 a[232:235], a[248:251], v[192:195], a[232:235]
    ds_read_b64_tr_b16 a[172:173], v224 offset:256
    v_cvt_pk_bf16_f32 v200, v200, v201
    v_fma_f32 v202, v202, s32, v219
    v_mfma_f32_16x16x32_bf16 v[192:195], a[128:131], a[64:67], 0
    v_exp_f32 v202, v202
    v_fma_f32 v203, v203, s32, v219
    v_mfma_f32_16x16x32_bf16 v[192:195], a[132:135], a[68:71], v[192:195]
    ds_read_b64_tr_b16 a[174:175], v224 offset:1280
    v_exp_f32 v203, v203
    v_mfma_f32_16x16x32_bf16 v[192:195], a[136:139], a[72:75], v[192:195]
    v_cvt_pk_bf16_f32 v201, v202, v203
    v_fma_f32 v204, v204, s32, v219
    v_fma_f32 v205, v205, s32, v219
    v_mfma_f32_16x16x32_bf16 v[192:195], a[140:143], a[76:79], v[192:195]
    ds_read_b64_tr_b16 a[176:177], v223 offset:512
    v_exp_f32 v204, v204
    v_mfma_f32_16x16x32_bf16 v[196:199], a[144:147], a[64:67], 0
    v_exp_f32 v205, v205
    v_fma_f32 v206, v206, s32, v219
    v_mfma_f32_16x16x32_bf16 v[196:199], a[148:151], a[68:71], v[196:199]
    v_exp_f32 v206, v206
    v_fma_f32 v207, v207, s32, v219
    v_exp_f32 v207, v207
    v_mfma_f32_16x16x32_bf16 v[196:199], a[152:155], a[72:75], v[196:199]
    v_cvt_pk_bf16_f32 v202, v204, v205
    v_cvt_pk_bf16_f32 v203, v206, v207
    v_mfma_f32_16x16x32_bf16 v[196:199], a[156:159], a[76:79], v[196:199]
    ds_read_b64_tr_b16 a[178:179], v223 offset:1536
    ds_read_b64_tr_b16 a[180:181], v224 offset:512
    v_mfma_f32_16x16x32_bf16 v[96:99], a[192:195], v[200:203], v[96:99]
    v_fma_f32 v192, v192, s32, v220
    v_fma_f32 v193, v193, s32, v220
    v_mfma_f32_16x16x32_bf16 v[100:103], a[196:199], v[200:203], v[100:103]
    v_exp_f32 v192, v192
    v_mfma_f32_16x16x32_bf16 v[104:107], a[200:203], v[200:203], v[104:107]
    ds_read_b64_tr_b16 a[182:183], v224 offset:1536
    v_fma_f32 v194, v194, s32, v220
    v_mfma_f32_16x16x32_bf16 v[108:111], a[204:207], v[200:203], v[108:111]
    v_exp_f32 v193, v193
    v_mfma_f32_16x16x32_bf16 v[112:115], a[208:211], v[200:203], v[112:115]
    ds_read_b64_tr_b16 a[184:185], v223 offset:768
    v_cvt_pk_bf16_f32 v192, v192, v193
    v_mfma_f32_16x16x32_bf16 v[116:119], a[212:215], v[200:203], v[116:119]
    v_exp_f32 v194, v194
    v_mfma_f32_16x16x32_bf16 v[120:123], a[216:219], v[200:203], v[120:123]
    v_fma_f32 v195, v195, s32, v220
    v_fma_f32 v196, v196, s32, v220
    v_mfma_f32_16x16x32_bf16 v[124:127], a[220:223], v[200:203], v[124:127]
    v_exp_f32 v195, v195
    v_mfma_f32_16x16x32_bf16 a[236:239], a[248:251], v[200:203], a[236:239]
    ds_read_b64_tr_b16 a[186:187], v223 offset:1792
    v_cvt_pk_bf16_f32 v193, v194, v195
    v_mfma_f32_16x16x32_bf16 v[200:203], a[128:131], a[80:83], 0
    v_exp_f32 v196, v196
    v_mfma_f32_16x16x32_bf16 v[200:203], a[132:135], a[84:87], v[200:203]
    ds_read_b64_tr_b16 a[188:189], v224 offset:768
    v_fma_f32 v197, v197, s32, v220
    v_mfma_f32_16x16x32_bf16 v[200:203], a[136:139], a[88:91], v[200:203]
    v_exp_f32 v197, v197
    v_mfma_f32_16x16x32_bf16 v[200:203], a[140:143], a[92:95], v[200:203]
    v_cvt_pk_bf16_f32 v194, v196, v197
    v_fma_f32 v198, v198, s32, v220
    v_mfma_f32_16x16x32_bf16 v[204:207], a[144:147], a[80:83], 0
    v_exp_f32 v198, v198
    v_mfma_f32_16x16x32_bf16 v[204:207], a[148:151], a[84:87], v[204:207]
    s_waitcnt lgkmcnt(15)
    v_fma_f32 v199, v199, s32, v220
    v_exp_f32 v199, v199
    v_mfma_f32_16x16x32_bf16 v[204:207], a[152:155], a[88:91], v[204:207]
    ds_read_b64_tr_b16 a[190:191], v224 offset:1792
    v_cvt_pk_bf16_f32 v195, v198, v199
    v_mfma_f32_16x16x32_bf16 v[204:207], a[156:159], a[92:95], v[204:207]
    v_fma_f32 v200, v200, s32, v221
    v_fma_f32 v201, v201, s32, v221
    v_mfma_f32_16x16x32_bf16 v[128:131], a[192:195], v[192:195], v[128:131]
    s_waitcnt vmcnt(14)
    v_mfma_f32_16x16x32_bf16 v[132:135], a[196:199], v[192:195], v[132:135]
    s_barrier
    v_mfma_f32_16x16x32_bf16 v[136:139], a[200:203], v[192:195], v[136:139]
    v_exp_f32 v200, v200
    v_mfma_f32_16x16x32_bf16 v[140:143], a[204:207], v[192:195], v[140:143]
    v_exp_f32 v201, v201
    v_mfma_f32_16x16x32_bf16 v[144:147], a[208:211], v[192:195], v[144:147]
    ds_read_b128 a[128:131], v222 offset:8192
    v_cvt_pk_bf16_f32 v200, v200, v201
    v_mfma_f32_16x16x32_bf16 v[148:151], a[212:215], v[192:195], v[148:151]
    ds_read_b128 a[132:135], v222 offset:8448
    v_fma_f32 v202, v202, s32, v221
    v_mfma_f32_16x16x32_bf16 v[152:155], a[216:219], v[192:195], v[152:155]
    ds_read_b128 a[136:139], v222 offset:8704
    v_fma_f32 v203, v203, s32, v221
    v_mfma_f32_16x16x32_bf16 v[156:159], a[220:223], v[192:195], v[156:159]
    ds_read_b128 a[140:143], v222 offset:8960
    v_fma_f32 v204, v204, s32, v221
    v_mfma_f32_16x16x32_bf16 a[240:243], a[248:251], v[192:195], a[240:243]
    ds_read_b128 a[144:147], v222 offset:9216
    v_fma_f32 v205, v205, s32, v221
    v_mfma_f32_16x16x32_bf16 v[192:195], a[96:99], a[0:3], 0
    ds_read_b128 a[148:151], v222 offset:9472
    v_fma_f32 v206, v206, s32, v221
    v_mfma_f32_16x16x32_bf16 v[192:195], a[100:103], a[4:7], v[192:195]
    ds_read_b128 a[152:155], v222 offset:9728
    v_add_u32 v227, 0xffffa000, v227
    v_mfma_f32_16x16x32_bf16 v[192:195], a[104:107], a[8:11], v[192:195]
    ds_read_b128 a[156:159], v222 offset:9984
    v_fma_f32 v207, v207, s32, v221
    v_mfma_f32_16x16x32_bf16 v[192:195], a[108:111], a[12:15], v[192:195]
    v_exp_f32 v202, v202
    v_mfma_f32_16x16x32_bf16 v[196:199], a[112:115], a[0:3], 0
    v_exp_f32 v203, v203
    v_mfma_f32_16x16x32_bf16 v[196:199], a[116:119], a[4:7], v[196:199]
    v_cvt_pk_bf16_f32 v201, v202, v203
    v_mfma_f32_16x16x32_bf16 v[196:199], a[120:123], a[8:11], v[196:199]
    v_exp_f32 v204, v204
    v_mfma_f32_16x16x32_bf16 v[196:199], a[124:127], a[12:15], v[196:199]
    s_waitcnt lgkmcnt(0)
    v_exp_f32 v205, v205
    v_mfma_f32_16x16x32_bf16 v[208:211], a[128:131], a[0:3], 0
    v_cvt_pk_bf16_f32 v202, v204, v205
    v_fma_f32 v192, v192, s32, v216
    v_mfma_f32_16x16x32_bf16 v[208:211], a[132:135], a[4:7], v[208:211]
    v_exp_f32 v206, v206
    v_mfma_f32_16x16x32_bf16 v[208:211], a[136:139], a[8:11], v[208:211]
    v_exp_f32 v207, v207
    v_mfma_f32_16x16x32_bf16 v[208:211], a[140:143], a[12:15], v[208:211]
    v_cvt_pk_bf16_f32 v203, v206, v207
    v_fma_f32 v193, v193, s32, v216
    v_mfma_f32_16x16x32_bf16 v[212:215], a[144:147], a[0:3], 0
    v_exp_f32 v192, v192
    v_mfma_f32_16x16x32_bf16 v[212:215], a[148:151], a[4:7], v[212:215]
    v_exp_f32 v193, v193
    v_mfma_f32_16x16x32_bf16 v[212:215], a[152:155], a[8:11], v[212:215]
    v_cvt_pk_bf16_f32 v192, v192, v193
    v_fma_f32 v194, v194, s32, v216
    v_mfma_f32_16x16x32_bf16 v[212:215], a[156:159], a[12:15], v[212:215]
    v_exp_f32 v194, v194
    v_mfma_f32_16x16x32_bf16 v[160:163], a[192:195], v[200:203], v[160:163]
    v_fma_f32 v195, v195, s32, v216
    v_fma_f32 v196, v196, s32, v216
    v_mfma_f32_16x16x32_bf16 v[164:167], a[196:199], v[200:203], v[164:167]
    v_exp_f32 v195, v195
    v_mfma_f32_16x16x32_bf16 v[168:171], a[200:203], v[200:203], v[168:171]
    ds_read_b64_tr_b16 a[192:193], v223 offset:8192
    v_cvt_pk_bf16_f32 v193, v194, v195
    v_mfma_f32_16x16x32_bf16 v[172:175], a[204:207], v[200:203], v[172:175]
    v_exp_f32 v196, v196
    v_mfma_f32_16x16x32_bf16 v[176:179], a[208:211], v[200:203], v[176:179]
    ds_read_b64_tr_b16 a[194:195], v223 offset:9216
    v_fma_f32 v197, v197, s32, v216
    v_mfma_f32_16x16x32_bf16 v[180:183], a[212:215], v[200:203], v[180:183]
    ds_read_b64_tr_b16 a[196:197], v224 offset:8192
    ds_read_b64_tr_b16 a[198:199], v224 offset:9216
    v_mfma_f32_16x16x32_bf16 v[184:187], a[216:219], v[200:203], v[184:187]
    v_exp_f32 v197, v197
    v_mfma_f32_16x16x32_bf16 v[188:191], a[220:223], v[200:203], v[188:191]
    v_cvt_pk_bf16_f32 v194, v196, v197
    v_fma_f32 v198, v198, s32, v216
    v_mfma_f32_16x16x32_bf16 a[244:247], a[248:251], v[200:203], a[244:247]
    ds_read_b64_tr_b16 a[200:201], v223 offset:8448
    ds_read_b64_tr_b16 a[202:203], v223 offset:9472
    v_mfma_f32_16x16x32_bf16 v[200:203], a[96:99], a[16:19], 0
    v_exp_f32 v198, v198
    v_mfma_f32_16x16x32_bf16 v[200:203], a[100:103], a[20:23], v[200:203]
    ds_read_b64_tr_b16 a[204:205], v224 offset:8448
    v_fma_f32 v199, v199, s32, v216
    v_mfma_f32_16x16x32_bf16 v[200:203], a[104:107], a[24:27], v[200:203]
    v_exp_f32 v199, v199
    v_mfma_f32_16x16x32_bf16 v[200:203], a[108:111], a[28:31], v[200:203]
    ds_read_b64_tr_b16 a[206:207], v224 offset:9472
    v_cvt_pk_bf16_f32 v195, v198, v199
    v_mfma_f32_16x16x32_bf16 v[204:207], a[112:115], a[16:19], 0
    ds_read_b64_tr_b16 a[208:209], v223 offset:8704
    ds_read_b64_tr_b16 a[210:211], v223 offset:9728
    v_fma_f32 v208, v208, s32, v216
    v_mfma_f32_16x16x32_bf16 v[204:207], a[116:119], a[20:23], v[204:207]
    v_exp_f32 v208, v208
    v_fma_f32 v209, v209, s32, v216
    v_mfma_f32_16x16x32_bf16 v[204:207], a[120:123], a[24:27], v[204:207]
    ds_read_b64_tr_b16 a[212:213], v224 offset:8704
    v_exp_f32 v209, v209
    v_mfma_f32_16x16x32_bf16 v[204:207], a[124:127], a[28:31], v[204:207]
    ds_read_b64_tr_b16 a[214:215], v224 offset:9728
    v_cvt_pk_bf16_f32 v208, v208, v209
    v_fma_f32 v210, v210, s32, v216
    v_mfma_f32_16x16x32_bf16 v[248:251], a[128:131], a[16:19], 0
    ds_read_b64_tr_b16 a[216:217], v223 offset:8960
    ds_read_b64_tr_b16 a[218:219], v223 offset:9984
    v_exp_f32 v210, v210
    v_mfma_f32_16x16x32_bf16 v[248:251], a[132:135], a[20:23], v[248:251]
    ds_read_b64_tr_b16 a[220:221], v224 offset:8960
    v_fma_f32 v211, v211, s32, v216
    v_exp_f32 v211, v211
    v_mfma_f32_16x16x32_bf16 v[248:251], a[136:139], a[24:27], v[248:251]
    ds_read_b64_tr_b16 a[222:223], v224 offset:9984
    v_cvt_pk_bf16_f32 v209, v210, v211
    v_fma_f32 v212, v212, s32, v216
    v_fma_f32 v200, v200, s32, v217
    v_mfma_f32_16x16x32_bf16 v[248:251], a[140:143], a[28:31], v[248:251]
    v_exp_f32 v212, v212
    v_fma_f32 v213, v213, s32, v216
    v_fma_f32 v201, v201, s32, v217
    v_mfma_f32_16x16x32_bf16 v[252:255], a[144:147], a[16:19], 0
    v_exp_f32 v200, v200
    v_exp_f32 v213, v213
    v_mfma_f32_16x16x32_bf16 v[252:255], a[148:151], a[20:23], v[252:255]
    v_fma_f32 v214, v214, s32, v216
    v_exp_f32 v214, v214
    v_fma_f32 v215, v215, s32, v216
    v_exp_f32 v215, v215
    v_mfma_f32_16x16x32_bf16 v[252:255], a[152:155], a[24:27], v[252:255]
    v_cvt_pk_bf16_f32 v210, v212, v213
    v_cvt_pk_bf16_f32 v211, v214, v215
    v_mfma_f32_16x16x32_bf16 v[252:255], a[156:159], a[28:31], v[252:255]
    s_waitcnt lgkmcnt(0)
    v_exp_f32 v201, v201
    v_mfma_f32_16x16x32_bf16 a[224:227], a[248:251], v[192:195], a[224:227]
    v_cvt_pk_bf16_f32 v200, v200, v201
    v_fma_f32 v202, v202, s32, v217
    v_mfma_f32_16x16x32_bf16 a[224:227], a[248:251], v[208:211], a[224:227]
    v_exp_f32 v202, v202
    v_mfma_f32_16x16x32_bf16 v[0:3], a[160:163], v[192:195], v[0:3]
    v_fma_f32 v203, v203, s32, v217
    v_fma_f32 v204, v204, s32, v217
    v_mfma_f32_16x16x32_bf16 v[0:3], a[192:195], v[208:211], v[0:3]
    v_exp_f32 v203, v203
    v_mfma_f32_16x16x32_bf16 v[4:7], a[164:167], v[192:195], v[4:7]
    v_cvt_pk_bf16_f32 v201, v202, v203
    v_fma_f32 v205, v205, s32, v217
    v_mfma_f32_16x16x32_bf16 v[4:7], a[196:199], v[208:211], v[4:7]
    v_exp_f32 v204, v204
    v_mfma_f32_16x16x32_bf16 v[8:11], a[168:171], v[192:195], v[8:11]
    v_exp_f32 v205, v205
    v_mfma_f32_16x16x32_bf16 v[8:11], a[200:203], v[208:211], v[8:11]
    v_cvt_pk_bf16_f32 v202, v204, v205
    v_fma_f32 v206, v206, s32, v217
    v_mfma_f32_16x16x32_bf16 v[12:15], a[172:175], v[192:195], v[12:15]
    v_accvgpr_read_b32 v222, a224
    v_fma_f32 v207, v207, s32, v217
    v_mfma_f32_16x16x32_bf16 v[12:15], a[204:207], v[208:211], v[12:15]
    v_rcp_f32 v246, v222
    v_mfma_f32_16x16x32_bf16 v[16:19], a[176:179], v[192:195], v[16:19]
    v_cmp_nge_f32 vcc, 0x4e800000, v222
    v_mul_f32 v0, v246, v0
    v_mfma_f32_16x16x32_bf16 v[16:19], a[208:211], v[208:211], v[16:19]
    v_exp_f32 v206, v206
    v_mul_f32 v1, v246, v1
    v_mfma_f32_16x16x32_bf16 v[20:23], a[180:183], v[192:195], v[20:23]
    s_or_b64 s[52:53], s[52:53], vcc
    v_cvt_pk_bf16_f32 v0, v0, v1
    v_mul_f32 v2, v246, v2
    v_mul_f32 v3, v246, v3
    v_mfma_f32_16x16x32_bf16 v[20:23], a[212:215], v[208:211], v[20:23]
    v_cvt_pk_bf16_f32 v1, v2, v3
    v_mul_f32 v8, v246, v8
    v_mul_f32 v9, v246, v9
    v_mfma_f32_16x16x32_bf16 v[24:27], a[184:187], v[192:195], v[24:27]
    v_cvt_pk_bf16_f32 v8, v8, v9
    v_mul_f32 v10, v246, v10
    v_mul_f32 v11, v246, v11
    v_mfma_f32_16x16x32_bf16 v[24:27], a[216:219], v[208:211], v[24:27]
    v_cvt_pk_bf16_f32 v9, v10, v11
    v_exp_f32 v207, v207
    v_fma_f32 v248, v248, s32, v217
    v_mfma_f32_16x16x32_bf16 v[28:31], a[188:191], v[192:195], v[28:31]
    ds_write2_b64 v225, v[0:1], v[8:9] offset0:0 offset1:32
    v_mfma_f32_16x16x32_bf16 v[28:31], a[220:223], v[208:211], v[28:31]
    v_cvt_pk_bf16_f32 v203, v206, v207
    v_exp_f32 v248, v248
    v_fma_f32 v249, v249, s32, v217
    v_mul_f32 v4, v246, v4
    v_mfma_f32_16x16x32_bf16 v[192:195], a[96:99], a[32:35], 0
    v_mul_f32 v5, v246, v5
    v_cvt_pk_bf16_f32 v4, v4, v5
    v_mul_f32 v6, v246, v6
    v_mul_f32 v7, v246, v7
    v_cvt_pk_bf16_f32 v5, v6, v7
    v_mfma_f32_16x16x32_bf16 v[192:195], a[100:103], a[36:39], v[192:195]
    v_mul_f32 v12, v246, v12
    v_mul_f32 v13, v246, v13
    v_cvt_pk_bf16_f32 v12, v12, v13
    v_mul_f32 v14, v246, v14
    v_mul_f32 v15, v246, v15
    v_mfma_f32_16x16x32_bf16 v[192:195], a[104:107], a[40:43], v[192:195]
    v_cvt_pk_bf16_f32 v13, v14, v15
    v_exp_f32 v249, v249
    v_fma_f32 v250, v250, s32, v217
    v_fma_f32 v251, v251, s32, v217
    v_mfma_f32_16x16x32_bf16 v[192:195], a[108:111], a[44:47], v[192:195]
    ds_write2_b64 v226, v[4:5], v[12:13] offset0:0 offset1:32
    v_mfma_f32_16x16x32_bf16 v[196:199], a[112:115], a[32:35], 0
    v_cvt_pk_bf16_f32 v248, v248, v249
    v_exp_f32 v250, v250
    v_mul_f32 v16, v246, v16
    v_mul_f32 v17, v246, v17
    v_mfma_f32_16x16x32_bf16 v[196:199], a[116:119], a[36:39], v[196:199]
    v_cvt_pk_bf16_f32 v16, v16, v17
    v_mul_f32 v18, v246, v18
    v_mul_f32 v19, v246, v19
    v_cvt_pk_bf16_f32 v17, v18, v19
    v_mul_f32 v24, v246, v24
    v_mfma_f32_16x16x32_bf16 v[196:199], a[120:123], a[40:43], v[196:199]
    v_mul_f32 v25, v246, v25
    v_cvt_pk_bf16_f32 v24, v24, v25
    v_mul_f32 v26, v246, v26
    v_mul_f32 v27, v246, v27
    v_cvt_pk_bf16_f32 v25, v26, v27
    v_mfma_f32_16x16x32_bf16 v[196:199], a[124:127], a[44:47], v[196:199]
    ds_write2_b64 v225, v[16:17], v[24:25] offset0:64 offset1:96
    v_mfma_f32_16x16x32_bf16 v[208:211], a[128:131], a[32:35], 0
    v_exp_f32 v251, v251
    v_fma_f32 v252, v252, s32, v217
    v_exp_f32 v252, v252
    v_mfma_f32_16x16x32_bf16 v[208:211], a[132:135], a[36:39], v[208:211]
    v_cvt_pk_bf16_f32 v249, v250, v251
    v_fma_f32 v253, v253, s32, v217
    v_mul_f32 v20, v246, v20
    v_mul_f32 v21, v246, v21
    v_cvt_pk_bf16_f32 v20, v20, v21
    v_mfma_f32_16x16x32_bf16 v[208:211], a[136:139], a[40:43], v[208:211]
    v_mul_f32 v22, v246, v22
    v_mul_f32 v23, v246, v23
    v_cvt_pk_bf16_f32 v21, v22, v23
    v_mul_f32 v28, v246, v28
    v_mul_f32 v29, v246, v29
    v_mfma_f32_16x16x32_bf16 v[208:211], a[140:143], a[44:47], v[208:211]
    v_cvt_pk_bf16_f32 v28, v28, v29
    v_mul_f32 v30, v246, v30
    v_mul_f32 v31, v246, v31
    v_cvt_pk_bf16_f32 v29, v30, v31
    v_fma_f32 v254, v254, s32, v217
    v_mfma_f32_16x16x32_bf16 v[212:215], a[144:147], a[32:35], 0
    ds_write2_b64 v226, v[20:21], v[28:29] offset0:64 offset1:96
    v_mfma_f32_16x16x32_bf16 v[212:215], a[148:151], a[36:39], v[212:215]
    v_exp_f32 v253, v253
    v_exp_f32 v254, v254
    v_fma_f32 v255, v255, s32, v217
    v_exp_f32 v255, v255
    v_mfma_f32_16x16x32_bf16 v[212:215], a[152:155], a[40:43], v[212:215]
    v_cvt_pk_bf16_f32 v250, v252, v253
    v_cvt_pk_bf16_f32 v251, v254, v255
    v_mfma_f32_16x16x32_bf16 v[212:215], a[156:159], a[44:47], v[212:215]
    ds_read_b128 v[228:231], v227 offset:0
    v_fma_f32 v192, v192, s32, v218
    v_mfma_f32_16x16x32_bf16 a[228:231], a[248:251], v[200:203], a[228:231]
    ds_read_b128 v[232:235], v227 offset:1024
    v_fma_f32 v193, v193, s32, v218
    v_mfma_f32_16x16x32_bf16 a[228:231], a[248:251], v[248:251], a[228:231]
    ds_read_b128 v[236:239], v227 offset:2048
    v_fma_f32 v194, v194, s32, v218
    v_mfma_f32_16x16x32_bf16 v[32:35], a[160:163], v[200:203], v[32:35]
    ds_read_b128 v[240:243], v227 offset:3072
    v_fma_f32 v195, v195, s32, v218
    v_mfma_f32_16x16x32_bf16 v[32:35], a[192:195], v[248:251], v[32:35]
    v_exp_f32 v192, v192
    v_mfma_f32_16x16x32_bf16 v[36:39], a[164:167], v[200:203], v[36:39]
    v_exp_f32 v193, v193
    v_mfma_f32_16x16x32_bf16 v[36:39], a[196:199], v[248:251], v[36:39]
    v_cvt_pk_bf16_f32 v192, v192, v193
    v_fma_f32 v196, v196, s32, v218
    v_mfma_f32_16x16x32_bf16 v[40:43], a[168:171], v[200:203], v[40:43]
    v_exp_f32 v194, v194
    v_mfma_f32_16x16x32_bf16 v[40:43], a[200:203], v[248:251], v[40:43]
    s_waitcnt lgkmcnt(0)
    buffer_store_dwordx4 v[228:231], v244, s[20:23], s40 offen nt
    v_mfma_f32_16x16x32_bf16 v[44:47], a[172:175], v[200:203], v[44:47]
    v_exp_f32 v195, v195
    v_fma_f32 v197, v197, s32, v218
    v_mfma_f32_16x16x32_bf16 v[44:47], a[204:207], v[248:251], v[44:47]
    v_cvt_pk_bf16_f32 v193, v194, v195
    v_exp_f32 v196, v196
    v_mfma_f32_16x16x32_bf16 v[48:51], a[176:179], v[200:203], v[48:51]
    v_exp_f32 v197, v197
    v_fma_f32 v198, v198, s32, v218
    v_mfma_f32_16x16x32_bf16 v[48:51], a[208:211], v[248:251], v[48:51]
    buffer_store_dwordx4 v[232:235], v245, s[20:23], s40 offen offset:1024 nt
    v_mfma_f32_16x16x32_bf16 v[52:55], a[180:183], v[200:203], v[52:55]
    v_cvt_pk_bf16_f32 v194, v196, v197
    v_accvgpr_read_b32 v222, a228
    v_rcp_f32 v247, v222
    v_mfma_f32_16x16x32_bf16 v[52:55], a[212:215], v[248:251], v[52:55]
    v_cmp_nge_f32 vcc, 0x4e800000, v222
    v_exp_f32 v198, v198
    v_fma_f32 v199, v199, s32, v218
    v_mfma_f32_16x16x32_bf16 v[56:59], a[184:187], v[200:203], v[56:59]
    v_mul_f32 v32, v247, v32
    v_mul_f32 v33, v247, v33
    v_cvt_pk_bf16_f32 v32, v32, v33
    v_mul_f32 v34, v247, v34
    v_mfma_f32_16x16x32_bf16 v[56:59], a[216:219], v[248:251], v[56:59]
    buffer_store_dwordx4 v[236:239], v244, s[20:23], s40 offen offset:2048 nt
    v_mfma_f32_16x16x32_bf16 v[60:63], a[188:191], v[200:203], v[60:63]
    s_or_b64 s[52:53], s[52:53], vcc
    v_mul_f32 v35, v247, v35
    v_cvt_pk_bf16_f32 v33, v34, v35
    v_mul_f32 v40, v247, v40
    v_mul_f32 v41, v247, v41
    v_cvt_pk_bf16_f32 v40, v40, v41
    v_mfma_f32_16x16x32_bf16 v[60:63], a[220:223], v[248:251], v[60:63]
    v_mul_f32 v42, v247, v42
    v_mul_f32 v43, v247, v43
    v_cvt_pk_bf16_f32 v41, v42, v43
    v_exp_f32 v199, v199
    v_fma_f32 v208, v208, s32, v218
    v_mfma_f32_16x16x32_bf16 v[200:203], a[96:99], a[48:51], 0
    ds_write2_b64 v225, v[32:33], v[40:41] offset0:0 offset1:32
    v_cvt_pk_bf16_f32 v195, v198, v199
    v_mfma_f32_16x16x32_bf16 v[200:203], a[100:103], a[52:55], v[200:203]
    buffer_store_dwordx4 v[240:243], v245, s[20:23], s40 offen offset:3072 nt
    v_mfma_f32_16x16x32_bf16 v[200:203], a[104:107], a[56:59], v[200:203]
    s_add_u32 s40, s40, 0x1000
    v_exp_f32 v208, v208
    v_fma_f32 v209, v209, s32, v218
    v_mul_f32 v36, v247, v36
    v_mul_f32 v37, v247, v37
    v_cvt_pk_bf16_f32 v36, v36, v37
    v_mfma_f32_16x16x32_bf16 v[200:203], a[108:111], a[60:63], v[200:203]
    v_mul_f32 v38, v247, v38
    v_mul_f32 v39, v247, v39
    v_cvt_pk_bf16_f32 v37, v38, v39
    v_mul_f32 v44, v247, v44
    v_mul_f32 v45, v247, v45
    v_cvt_pk_bf16_f32 v44, v44, v45
    v_mfma_f32_16x16x32_bf16 v[204:207], a[112:115], a[48:51], 0
    v_mul_f32 v46, v247, v46
    v_mul_f32 v47, v247, v47
    v_cvt_pk_bf16_f32 v45, v46, v47
    v_exp_f32 v209, v209
    v_fma_f32 v210, v210, s32, v218
    v_mfma_f32_16x16x32_bf16 v[204:207], a[116:119], a[52:55], v[204:207]
    ds_write2_b64 v226, v[36:37], v[44:45] offset0:0 offset1:32
    v_cvt_pk_bf16_f32 v208, v208, v209
    v_mfma_f32_16x16x32_bf16 v[204:207], a[120:123], a[56:59], v[204:207]
    v_exp_f32 v210, v210
    v_fma_f32 v211, v211, s32, v218
    v_mul_f32 v48, v247, v48
    v_mul_f32 v49, v247, v49
    v_cvt_pk_bf16_f32 v48, v48, v49
    v_mfma_f32_16x16x32_bf16 v[204:207], a[124:127], a[60:63], v[204:207]
    v_mul_f32 v50, v247, v50
    v_mul_f32 v51, v247, v51
    v_cvt_pk_bf16_f32 v49, v50, v51
    v_mul_f32 v56, v247, v56
    v_mul_f32 v57, v247, v57
    v_cvt_pk_bf16_f32 v56, v56, v57
    v_mfma_f32_16x16x32_bf16 v[248:251], a[128:131], a[48:51], 0
    v_mul_f32 v58, v247, v58
    v_mul_f32 v59, v247, v59
    v_cvt_pk_bf16_f32 v57, v58, v59
    v_exp_f32 v211, v211
    v_fma_f32 v212, v212, s32, v218
    v_mfma_f32_16x16x32_bf16 v[248:251], a[132:135], a[52:55], v[248:251]
    ds_write2_b64 v225, v[48:49], v[56:57] offset0:64 offset1:96
    v_cvt_pk_bf16_f32 v209, v210, v211
    v_mfma_f32_16x16x32_bf16 v[248:251], a[136:139], a[56:59], v[248:251]
    v_exp_f32 v212, v212
    v_fma_f32 v213, v213, s32, v218
    v_mul_f32 v52, v247, v52
    v_mul_f32 v53, v247, v53
    v_cvt_pk_bf16_f32 v52, v52, v53
    v_mfma_f32_16x16x32_bf16 v[248:251], a[140:143], a[60:63], v[248:251]
    v_mul_f32 v54, v247, v54
    v_mul_f32 v55, v247, v55
    v_cvt_pk_bf16_f32 v53, v54, v55
    v_mul_f32 v60, v247, v60
    v_mul_f32 v61, v247, v61
    v_cvt_pk_bf16_f32 v60, v60, v61
    v_mfma_f32_16x16x32_bf16 v[252:255], a[144:147], a[48:51], 0
    v_mul_f32 v62, v247, v62
    v_mul_f32 v63, v247, v63
    v_cvt_pk_bf16_f32 v61, v62, v63
    v_exp_f32 v213, v213
    v_fma_f32 v214, v214, s32, v218
    v_fma_f32 v215, v215, s32, v218
    v_mfma_f32_16x16x32_bf16 v[252:255], a[148:151], a[52:55], v[252:255]
    ds_write2_b64 v226, v[52:53], v[60:61] offset0:64 offset1:96
    v_exp_f32 v214, v214
    v_exp_f32 v215, v215
    v_mfma_f32_16x16x32_bf16 v[252:255], a[152:155], a[56:59], v[252:255]
    v_cvt_pk_bf16_f32 v210, v212, v213
    v_cvt_pk_bf16_f32 v211, v214, v215
    v_mfma_f32_16x16x32_bf16 v[252:255], a[156:159], a[60:63], v[252:255]
    ds_read_b128 v[228:231], v227 offset:0
    v_fma_f32 v200, v200, s32, v219
    v_mfma_f32_16x16x32_bf16 a[232:235], a[248:251], v[192:195], a[232:235]
    ds_read_b128 v[232:235], v227 offset:1024
    v_fma_f32 v201, v201, s32, v219
    v_mfma_f32_16x16x32_bf16 a[232:235], a[248:251], v[208:211], a[232:235]
    ds_read_b128 v[236:239], v227 offset:2048
    v_fma_f32 v202, v202, s32, v219
    v_mfma_f32_16x16x32_bf16 v[64:67], a[160:163], v[192:195], v[64:67]
    ds_read_b128 v[240:243], v227 offset:3072
    v_fma_f32 v203, v203, s32, v219
    v_mfma_f32_16x16x32_bf16 v[64:67], a[192:195], v[208:211], v[64:67]
    v_exp_f32 v200, v200
    v_mfma_f32_16x16x32_bf16 v[68:71], a[164:167], v[192:195], v[68:71]
    v_exp_f32 v201, v201
    v_mfma_f32_16x16x32_bf16 v[68:71], a[196:199], v[208:211], v[68:71]
    v_cvt_pk_bf16_f32 v200, v200, v201
    v_fma_f32 v204, v204, s32, v219
    v_mfma_f32_16x16x32_bf16 v[72:75], a[168:171], v[192:195], v[72:75]
    v_exp_f32 v202, v202
    v_mfma_f32_16x16x32_bf16 v[72:75], a[200:203], v[208:211], v[72:75]
    s_waitcnt lgkmcnt(0)
    buffer_store_dwordx4 v[228:231], v244, s[20:23], s40 offen nt
    v_mfma_f32_16x16x32_bf16 v[76:79], a[172:175], v[192:195], v[76:79]
    v_exp_f32 v203, v203
    v_fma_f32 v205, v205, s32, v219
    v_mfma_f32_16x16x32_bf16 v[76:79], a[204:207], v[208:211], v[76:79]
    v_cvt_pk_bf16_f32 v201, v202, v203
    v_exp_f32 v204, v204
    v_mfma_f32_16x16x32_bf16 v[80:83], a[176:179], v[192:195], v[80:83]
    v_exp_f32 v205, v205
    v_fma_f32 v206, v206, s32, v219
    v_mfma_f32_16x16x32_bf16 v[80:83], a[208:211], v[208:211], v[80:83]
    buffer_store_dwordx4 v[232:235], v245, s[20:23], s40 offen offset:1024 nt
    v_mfma_f32_16x16x32_bf16 v[84:87], a[180:183], v[192:195], v[84:87]
    v_cvt_pk_bf16_f32 v202, v204, v205
    v_accvgpr_read_b32 v222, a232
    v_rcp_f32 v246, v222
    v_mfma_f32_16x16x32_bf16 v[84:87], a[212:215], v[208:211], v[84:87]
    v_cmp_nge_f32 vcc, 0x4e800000, v222
    v_exp_f32 v206, v206
    v_fma_f32 v207, v207, s32, v219
    v_mfma_f32_16x16x32_bf16 v[88:91], a[184:187], v[192:195], v[88:91]
    v_mul_f32 v64, v246, v64
    v_mul_f32 v65, v246, v65
    v_cvt_pk_bf16_f32 v64, v64, v65
    v_mul_f32 v66, v246, v66
    v_mfma_f32_16x16x32_bf16 v[88:91], a[216:219], v[208:211], v[88:91]
    buffer_store_dwordx4 v[236:239], v244, s[20:23], s40 offen offset:2048 nt
    v_mfma_f32_16x16x32_bf16 v[92:95], a[188:191], v[192:195], v[92:95]
    s_or_b64 s[52:53], s[52:53], vcc
    v_mul_f32 v67, v246, v67
    v_cvt_pk_bf16_f32 v65, v66, v67
    v_mul_f32 v72, v246, v72
    v_mul_f32 v73, v246, v73
    v_cvt_pk_bf16_f32 v72, v72, v73
    v_mfma_f32_16x16x32_bf16 v[92:95], a[220:223], v[208:211], v[92:95]
    v_mul_f32 v74, v246, v74
    v_mul_f32 v75, v246, v75
    v_cvt_pk_bf16_f32 v73, v74, v75
    v_exp_f32 v207, v207
    v_fma_f32 v248, v248, s32, v219
    v_mfma_f32_16x16x32_bf16 v[192:195], a[96:99], a[64:67], 0
    ds_write2_b64 v225, v[64:65], v[72:73] offset0:0 offset1:32
    v_cvt_pk_bf16_f32 v203, v206, v207
    v_mfma_f32_16x16x32_bf16 v[192:195], a[100:103], a[68:71], v[192:195]
    buffer_store_dwordx4 v[240:243], v245, s[20:23], s40 offen offset:3072 nt
    v_mfma_f32_16x16x32_bf16 v[192:195], a[104:107], a[72:75], v[192:195]
    s_add_u32 s40, s40, 0x1000
    v_exp_f32 v248, v248
    v_fma_f32 v249, v249, s32, v219
    v_mul_f32 v68, v246, v68
    v_mul_f32 v69, v246, v69
    v_cvt_pk_bf16_f32 v68, v68, v69
    v_mfma_f32_16x16x32_bf16 v[192:195], a[108:111], a[76:79], v[192:195]
    v_mul_f32 v70, v246, v70
    v_mul_f32 v71, v246, v71
    v_cvt_pk_bf16_f32 v69, v70, v71
    v_mul_f32 v76, v246, v76
    v_mul_f32 v77, v246, v77
    v_cvt_pk_bf16_f32 v76, v76, v77
    v_mfma_f32_16x16x32_bf16 v[196:199], a[112:115], a[64:67], 0
    v_mul_f32 v78, v246, v78
    v_mul_f32 v79, v246, v79
    v_cvt_pk_bf16_f32 v77, v78, v79
    v_exp_f32 v249, v249
    v_fma_f32 v250, v250, s32, v219
    v_mfma_f32_16x16x32_bf16 v[196:199], a[116:119], a[68:71], v[196:199]
    ds_write2_b64 v226, v[68:69], v[76:77] offset0:0 offset1:32
    v_cvt_pk_bf16_f32 v248, v248, v249
    v_mfma_f32_16x16x32_bf16 v[196:199], a[120:123], a[72:75], v[196:199]
    v_exp_f32 v250, v250
    v_fma_f32 v251, v251, s32, v219
    v_mul_f32 v80, v246, v80
    v_mul_f32 v81, v246, v81
    v_cvt_pk_bf16_f32 v80, v80, v81
    v_mfma_f32_16x16x32_bf16 v[196:199], a[124:127], a[76:79], v[196:199]
    v_mul_f32 v82, v246, v82
    v_mul_f32 v83, v246, v83
    v_cvt_pk_bf16_f32 v81, v82, v83
    v_mul_f32 v88, v246, v88
    v_mul_f32 v89, v246, v89
    v_cvt_pk_bf16_f32 v88, v88, v89
    v_mfma_f32_16x16x32_bf16 v[208:211], a[128:131], a[64:67], 0
    v_mul_f32 v90, v246, v90
    v_mul_f32 v91, v246, v91
    v_cvt_pk_bf16_f32 v89, v90, v91
    v_exp_f32 v251, v251
    v_fma_f32 v252, v252, s32, v219
    v_mfma_f32_16x16x32_bf16 v[208:211], a[132:135], a[68:71], v[208:211]
    ds_write2_b64 v225, v[80:81], v[88:89] offset0:64 offset1:96
    v_cvt_pk_bf16_f32 v249, v250, v251
    v_mfma_f32_16x16x32_bf16 v[208:211], a[136:139], a[72:75], v[208:211]
    v_exp_f32 v252, v252
    v_fma_f32 v253, v253, s32, v219
    v_mul_f32 v84, v246, v84
    v_mul_f32 v85, v246, v85
    v_cvt_pk_bf16_f32 v84, v84, v85
    v_mfma_f32_16x16x32_bf16 v[208:211], a[140:143], a[76:79], v[208:211]
    v_mul_f32 v86, v246, v86
    v_mul_f32 v87, v246, v87
    v_cvt_pk_bf16_f32 v85, v86, v87
    v_mul_f32 v92, v246, v92
    v_mul_f32 v93, v246, v93
    v_cvt_pk_bf16_f32 v92, v92, v93
    v_mfma_f32_16x16x32_bf16 v[212:215], a[144:147], a[64:67], 0
    v_mul_f32 v94, v246, v94
    v_mul_f32 v95, v246, v95
    v_cvt_pk_bf16_f32 v93, v94, v95
    v_exp_f32 v253, v253
    v_fma_f32 v254, v254, s32, v219
    v_fma_f32 v255, v255, s32, v219
    v_mfma_f32_16x16x32_bf16 v[212:215], a[148:151], a[68:71], v[212:215]
    ds_write2_b64 v226, v[84:85], v[92:93] offset0:64 offset1:96
    v_exp_f32 v254, v254
    v_exp_f32 v255, v255
    v_mfma_f32_16x16x32_bf16 v[212:215], a[152:155], a[72:75], v[212:215]
    v_cvt_pk_bf16_f32 v250, v252, v253
    v_cvt_pk_bf16_f32 v251, v254, v255
    v_mfma_f32_16x16x32_bf16 v[212:215], a[156:159], a[76:79], v[212:215]
    ds_read_b128 v[228:231], v227 offset:0
    v_fma_f32 v192, v192, s32, v220
    v_mfma_f32_16x16x32_bf16 a[236:239], a[248:251], v[200:203], a[236:239]
    ds_read_b128 v[232:235], v227 offset:1024
    v_fma_f32 v193, v193, s32, v220
    v_mfma_f32_16x16x32_bf16 a[236:239], a[248:251], v[248:251], a[236:239]
    ds_read_b128 v[236:239], v227 offset:2048
    v_fma_f32 v194, v194, s32, v220
    v_mfma_f32_16x16x32_bf16 v[96:99], a[160:163], v[200:203], v[96:99]
    ds_read_b128 v[240:243], v227 offset:3072
    v_fma_f32 v195, v195, s32, v220
    v_mfma_f32_16x16x32_bf16 v[96:99], a[192:195], v[248:251], v[96:99]
    v_exp_f32 v192, v192
    v_mfma_f32_16x16x32_bf16 v[100:103], a[164:167], v[200:203], v[100:103]
    v_exp_f32 v193, v193
    v_mfma_f32_16x16x32_bf16 v[100:103], a[196:199], v[248:251], v[100:103]
    v_cvt_pk_bf16_f32 v192, v192, v193
    v_fma_f32 v196, v196, s32, v220
    v_mfma_f32_16x16x32_bf16 v[104:107], a[168:171], v[200:203], v[104:107]
    v_exp_f32 v194, v194
    v_mfma_f32_16x16x32_bf16 v[104:107], a[200:203], v[248:251], v[104:107]
    s_waitcnt lgkmcnt(0)
    buffer_store_dwordx4 v[228:231], v244, s[20:23], s40 offen nt
    v_mfma_f32_16x16x32_bf16 v[108:111], a[172:175], v[200:203], v[108:111]
    v_exp_f32 v195, v195
    v_fma_f32 v197, v197, s32, v220
    v_mfma_f32_16x16x32_bf16 v[108:111], a[204:207], v[248:251], v[108:111]
    v_cvt_pk_bf16_f32 v193, v194, v195
    v_exp_f32 v196, v196
    v_mfma_f32_16x16x32_bf16 v[112:115], a[176:179], v[200:203], v[112:115]
    v_exp_f32 v197, v197
    v_fma_f32 v198, v198, s32, v220
    v_mfma_f32_16x16x32_bf16 v[112:115], a[208:211], v[248:251], v[112:115]
    buffer_store_dwordx4 v[232:235], v245, s[20:23], s40 offen offset:1024 nt
    v_mfma_f32_16x16x32_bf16 v[116:119], a[180:183], v[200:203], v[116:119]
    v_cvt_pk_bf16_f32 v194, v196, v197
    v_accvgpr_read_b32 v222, a236
    v_rcp_f32 v247, v222
    v_mfma_f32_16x16x32_bf16 v[116:119], a[212:215], v[248:251], v[116:119]
    v_cmp_nge_f32 vcc, 0x4e800000, v222
    v_exp_f32 v198, v198
    v_fma_f32 v199, v199, s32, v220
    v_mfma_f32_16x16x32_bf16 v[120:123], a[184:187], v[200:203], v[120:123]
    v_mul_f32 v96, v247, v96
    v_mul_f32 v97, v247, v97
    v_cvt_pk_bf16_f32 v96, v96, v97
    v_mul_f32 v98, v247, v98
    v_mfma_f32_16x16x32_bf16 v[120:123], a[216:219], v[248:251], v[120:123]
    buffer_store_dwordx4 v[236:239], v244, s[20:23], s40 offen offset:2048 nt
    v_mfma_f32_16x16x32_bf16 v[124:127], a[188:191], v[200:203], v[124:127]
    s_or_b64 s[52:53], s[52:53], vcc
    v_mul_f32 v99, v247, v99
    v_cvt_pk_bf16_f32 v97, v98, v99
    v_mul_f32 v104, v247, v104
    v_mul_f32 v105, v247, v105
    v_cvt_pk_bf16_f32 v104, v104, v105
    v_mfma_f32_16x16x32_bf16 v[124:127], a[220:223], v[248:251], v[124:127]
    v_mul_f32 v106, v247, v106
    v_mul_f32 v107, v247, v107
    v_cvt_pk_bf16_f32 v105, v106, v107
    v_exp_f32 v199, v199
    v_fma_f32 v208, v208, s32, v220
    v_mfma_f32_16x16x32_bf16 v[200:203], a[96:99], a[80:83], 0
    ds_write2_b64 v225, v[96:97], v[104:105] offset0:0 offset1:32
    v_cvt_pk_bf16_f32 v195, v198, v199
    v_mfma_f32_16x16x32_bf16 v[200:203], a[100:103], a[84:87], v[200:203]
    buffer_store_dwordx4 v[240:243], v245, s[20:23], s40 offen offset:3072 nt
    v_mfma_f32_16x16x32_bf16 v[200:203], a[104:107], a[88:91], v[200:203]
    s_add_u32 s40, s40, 0x1000
    v_exp_f32 v208, v208
    v_fma_f32 v209, v209, s32, v220
    v_mul_f32 v100, v247, v100
    v_mul_f32 v101, v247, v101
    v_cvt_pk_bf16_f32 v100, v100, v101
    v_mfma_f32_16x16x32_bf16 v[200:203], a[108:111], a[92:95], v[200:203]
    v_mul_f32 v102, v247, v102
    v_mul_f32 v103, v247, v103
    v_cvt_pk_bf16_f32 v101, v102, v103
    v_mul_f32 v108, v247, v108
    v_mul_f32 v109, v247, v109
    v_cvt_pk_bf16_f32 v108, v108, v109
    v_mfma_f32_16x16x32_bf16 v[204:207], a[112:115], a[80:83], 0
    v_mul_f32 v110, v247, v110
    v_mul_f32 v111, v247, v111
    v_cvt_pk_bf16_f32 v109, v110, v111
    v_exp_f32 v209, v209
    v_fma_f32 v210, v210, s32, v220
    v_mfma_f32_16x16x32_bf16 v[204:207], a[116:119], a[84:87], v[204:207]
    ds_write2_b64 v226, v[100:101], v[108:109] offset0:0 offset1:32
    v_cvt_pk_bf16_f32 v208, v208, v209
    v_mfma_f32_16x16x32_bf16 v[204:207], a[120:123], a[88:91], v[204:207]
    v_exp_f32 v210, v210
    v_fma_f32 v211, v211, s32, v220
    v_mul_f32 v112, v247, v112
    v_mul_f32 v113, v247, v113
    v_cvt_pk_bf16_f32 v112, v112, v113
    v_mfma_f32_16x16x32_bf16 v[204:207], a[124:127], a[92:95], v[204:207]
    v_mul_f32 v114, v247, v114
    v_mul_f32 v115, v247, v115
    v_cvt_pk_bf16_f32 v113, v114, v115
    v_mul_f32 v120, v247, v120
    v_mul_f32 v121, v247, v121
    v_cvt_pk_bf16_f32 v120, v120, v121
    v_mfma_f32_16x16x32_bf16 v[248:251], a[128:131], a[80:83], 0
    v_mul_f32 v122, v247, v122
    v_mul_f32 v123, v247, v123
    v_cvt_pk_bf16_f32 v121, v122, v123
    v_exp_f32 v211, v211
    v_fma_f32 v212, v212, s32, v220
    v_mfma_f32_16x16x32_bf16 v[248:251], a[132:135], a[84:87], v[248:251]
    ds_write2_b64 v225, v[112:113], v[120:121] offset0:64 offset1:96
    v_cvt_pk_bf16_f32 v209, v210, v211
    v_mfma_f32_16x16x32_bf16 v[248:251], a[136:139], a[88:91], v[248:251]
    v_exp_f32 v212, v212
    v_fma_f32 v213, v213, s32, v220
    v_mul_f32 v116, v247, v116
    v_mul_f32 v117, v247, v117
    v_cvt_pk_bf16_f32 v116, v116, v117
    v_mfma_f32_16x16x32_bf16 v[248:251], a[140:143], a[92:95], v[248:251]
    v_mul_f32 v118, v247, v118
    v_mul_f32 v119, v247, v119
    v_cvt_pk_bf16_f32 v117, v118, v119
    v_mul_f32 v124, v247, v124
    v_mul_f32 v125, v247, v125
    v_cvt_pk_bf16_f32 v124, v124, v125
    v_mfma_f32_16x16x32_bf16 v[252:255], a[144:147], a[80:83], 0
    v_mul_f32 v126, v247, v126
    v_mul_f32 v127, v247, v127
    v_cvt_pk_bf16_f32 v125, v126, v127
    v_exp_f32 v213, v213
    v_fma_f32 v214, v214, s32, v220
    v_fma_f32 v215, v215, s32, v220
    v_mfma_f32_16x16x32_bf16 v[252:255], a[148:151], a[84:87], v[252:255]
    ds_write2_b64 v226, v[116:117], v[124:125] offset0:64 offset1:96
    v_exp_f32 v214, v214
    v_exp_f32 v215, v215
    v_mfma_f32_16x16x32_bf16 v[252:255], a[152:155], a[88:91], v[252:255]
    v_cvt_pk_bf16_f32 v210, v212, v213
    v_cvt_pk_bf16_f32 v211, v214, v215
    v_mfma_f32_16x16x32_bf16 v[252:255], a[156:159], a[92:95], v[252:255]
    ds_read_b128 v[228:231], v227 offset:0
    v_fma_f32 v200, v200, s32, v221
    v_mfma_f32_16x16x32_bf16 a[240:243], a[248:251], v[192:195], a[240:243]
    ds_read_b128 v[232:235], v227 offset:1024
    v_fma_f32 v201, v201, s32, v221
    v_mfma_f32_16x16x32_bf16 a[240:243], a[248:251], v[208:211], a[240:243]
    ds_read_b128 v[236:239], v227 offset:2048
    v_fma_f32 v202, v202, s32, v221
    v_mfma_f32_16x16x32_bf16 v[128:131], a[160:163], v[192:195], v[128:131]
    ds_read_b128 v[240:243], v227 offset:3072
    v_fma_f32 v203, v203, s32, v221
    v_mfma_f32_16x16x32_bf16 v[128:131], a[192:195], v[208:211], v[128:131]
    v_exp_f32 v200, v200
    v_fma_f32 v204, v204, s32, v221
    v_mfma_f32_16x16x32_bf16 v[132:135], a[164:167], v[192:195], v[132:135]
    v_exp_f32 v201, v201
    v_fma_f32 v205, v205, s32, v221
    v_mfma_f32_16x16x32_bf16 v[132:135], a[196:199], v[208:211], v[132:135]
    v_cvt_pk_bf16_f32 v200, v200, v201
    v_exp_f32 v202, v202
    v_mfma_f32_16x16x32_bf16 v[136:139], a[168:171], v[192:195], v[136:139]
    v_exp_f32 v203, v203
    v_fma_f32 v206, v206, s32, v221
    v_mfma_f32_16x16x32_bf16 v[136:139], a[200:203], v[208:211], v[136:139]
    s_waitcnt lgkmcnt(0)
    buffer_store_dwordx4 v[228:231], v244, s[20:23], s40 offen nt
    v_mfma_f32_16x16x32_bf16 v[140:143], a[172:175], v[192:195], v[140:143]
    v_cvt_pk_bf16_f32 v201, v202, v203
    v_exp_f32 v204, v204
    v_exp_f32 v205, v205
    v_mfma_f32_16x16x32_bf16 v[140:143], a[204:207], v[208:211], v[140:143]
    v_cvt_pk_bf16_f32 v202, v204, v205
    v_accvgpr_read_b32 v222, a240
    v_rcp_f32 v246, v222
    v_cmp_nge_f32 vcc, 0x4e800000, v222
    v_mfma_f32_16x16x32_bf16 v[144:147], a[176:179], v[192:195], v[144:147]
    v_exp_f32 v206, v206
    v_fma_f32 v207, v207, s32, v221
    v_mul_f32 v128, v246, v128
    v_mul_f32 v129, v246, v129
    v_mfma_f32_16x16x32_bf16 v[144:147], a[208:211], v[208:211], v[144:147]
    buffer_store_dwordx4 v[232:235], v245, s[20:23], s40 offen offset:1024 nt
    v_mfma_f32_16x16x32_bf16 v[148:151], a[180:183], v[192:195], v[148:151]
    s_or_b64 s[52:53], s[52:53], vcc
    v_cvt_pk_bf16_f32 v128, v128, v129
    v_mul_f32 v130, v246, v130
    v_mul_f32 v131, v246, v131
    v_cvt_pk_bf16_f32 v129, v130, v131
    v_mul_f32 v136, v246, v136
    v_mul_f32 v137, v246, v137
    v_mfma_f32_16x16x32_bf16 v[148:151], a[212:215], v[208:211], v[148:151]
    v_cvt_pk_bf16_f32 v136, v136, v137
    v_mul_f32 v138, v246, v138
    v_mul_f32 v139, v246, v139
    v_cvt_pk_bf16_f32 v137, v138, v139
    v_exp_f32 v207, v207
    v_mfma_f32_16x16x32_bf16 v[152:155], a[184:187], v[192:195], v[152:155]
    ds_write2_b64 v225, v[128:129], v[136:137] offset0:0 offset1:32
    v_cvt_pk_bf16_f32 v203, v206, v207
    v_mfma_f32_16x16x32_bf16 v[152:155], a[216:219], v[208:211], v[152:155]
    buffer_store_dwordx4 v[236:239], v244, s[20:23], s40 offen offset:2048 nt
    v_fma_f32 v248, v248, s32, v221
    v_mfma_f32_16x16x32_bf16 v[156:159], a[188:191], v[192:195], v[156:159]
    v_exp_f32 v248, v248
    v_fma_f32 v249, v249, s32, v221
    v_mul_f32 v132, v246, v132
    v_mul_f32 v133, v246, v133
    v_cvt_pk_bf16_f32 v132, v132, v133
    v_mul_f32 v134, v246, v134
    v_mul_f32 v135, v246, v135
    v_mfma_f32_16x16x32_bf16 v[156:159], a[220:223], v[208:211], v[156:159]
    v_cvt_pk_bf16_f32 v133, v134, v135
    v_mul_f32 v140, v246, v140
    v_mul_f32 v141, v246, v141
    v_cvt_pk_bf16_f32 v140, v140, v141
    v_mul_f32 v142, v246, v142
    v_mul_f32 v143, v246, v143
    v_cvt_pk_bf16_f32 v141, v142, v143
    v_fma_f32 v250, v250, s32, v221
    ds_write2_b64 v226, v[132:133], v[140:141] offset0:0 offset1:32
    v_exp_f32 v249, v249
    v_exp_f32 v250, v250
    v_fma_f32 v251, v251, s32, v221
    buffer_store_dwordx4 v[240:243], v245, s[20:23], s40 offen offset:3072 nt
    v_cvt_pk_bf16_f32 v248, v248, v249
    v_mul_f32 v144, v246, v144
    v_mul_f32 v145, v246, v145
    s_add_u32 s40, s40, 0x1000
    v_cvt_pk_bf16_f32 v144, v144, v145
    v_mul_f32 v146, v246, v146
    v_mul_f32 v147, v246, v147
    v_cvt_pk_bf16_f32 v145, v146, v147
    v_mul_f32 v152, v246, v152
    v_mul_f32 v153, v246, v153
    v_cvt_pk_bf16_f32 v152, v152, v153
    v_mul_f32 v154, v246, v154
    v_mul_f32 v155, v246, v155
    v_cvt_pk_bf16_f32 v153, v154, v155
    v_exp_f32 v251, v251
    v_fma_f32 v252, v252, s32, v221
    v_exp_f32 v252, v252
    v_fma_f32 v253, v253, s32, v221
    v_mul_f32 v148, v246, v148
    v_mul_f32 v149, v246, v149
    v_cvt_pk_bf16_f32 v148, v148, v149
    ds_write2_b64 v225, v[144:145], v[152:153] offset0:64 offset1:96
    v_cvt_pk_bf16_f32 v249, v250, v251
    v_mul_f32 v150, v246, v150
    v_mul_f32 v151, v246, v151
    v_cvt_pk_bf16_f32 v149, v150, v151
    v_mul_f32 v156, v246, v156
    v_mul_f32 v157, v246, v157
    v_cvt_pk_bf16_f32 v156, v156, v157
    v_mul_f32 v158, v246, v158
    v_mul_f32 v159, v246, v159
    v_cvt_pk_bf16_f32 v157, v158, v159
    v_exp_f32 v253, v253
    v_fma_f32 v254, v254, s32, v221
    v_exp_f32 v254, v254
    v_fma_f32 v255, v255, s32, v221
    v_exp_f32 v255, v255
    ds_write2_b64 v226, v[148:149], v[156:157] offset0:64 offset1:96
    v_cvt_pk_bf16_f32 v250, v252, v253
    v_cvt_pk_bf16_f32 v251, v254, v255
    ds_read_b128 v[228:231], v227 offset:0
    v_mfma_f32_16x16x32_bf16 a[244:247], a[248:251], v[200:203], a[244:247]
    ds_read_b128 v[232:235], v227 offset:1024
    v_mfma_f32_16x16x32_bf16 a[244:247], a[248:251], v[248:251], a[244:247]
    ds_read_b128 v[236:239], v227 offset:2048
    v_mfma_f32_16x16x32_bf16 v[160:163], a[160:163], v[200:203], v[160:163]
    s_nop 0
    ds_read_b128 v[240:243], v227 offset:3072
    v_mfma_f32_16x16x32_bf16 v[160:163], a[192:195], v[248:251], v[160:163]
    s_nop 0
    v_mfma_f32_16x16x32_bf16 v[164:167], a[164:167], v[200:203], v[164:167]
    s_nop 0
    v_accvgpr_read_b32 v222, a244
    v_mfma_f32_16x16x32_bf16 v[164:167], a[196:199], v[248:251], v[164:167]
    v_rcp_f32 v247, v222
    v_mfma_f32_16x16x32_bf16 v[168:171], a[168:171], v[200:203], v[168:171]
    v_cmp_nge_f32 vcc, 0x4e800000, v222
    v_mul_f32 v160, v247, v160
    v_mfma_f32_16x16x32_bf16 v[168:171], a[200:203], v[248:251], v[168:171]
    s_waitcnt lgkmcnt(0)
    buffer_store_dwordx4 v[228:231], v244, s[20:23], s40 offen nt
    v_mfma_f32_16x16x32_bf16 v[172:175], a[172:175], v[200:203], v[172:175]
    s_or_b64 s[52:53], s[52:53], vcc
    v_mul_f32 v161, v247, v161
    v_cvt_pk_bf16_f32 v160, v160, v161
    v_mfma_f32_16x16x32_bf16 v[172:175], a[204:207], v[248:251], v[172:175]
    v_mul_f32 v162, v247, v162
    v_mul_f32 v163, v247, v163
    v_mfma_f32_16x16x32_bf16 v[176:179], a[176:179], v[200:203], v[176:179]
    v_cvt_pk_bf16_f32 v161, v162, v163
    v_mul_f32 v168, v247, v168
    v_mfma_f32_16x16x32_bf16 v[176:179], a[208:211], v[248:251], v[176:179]
    buffer_store_dwordx4 v[232:235], v245, s[20:23], s40 offen offset:1024 nt
    v_mfma_f32_16x16x32_bf16 v[180:183], a[180:183], v[200:203], v[180:183]
    v_mul_f32 v169, v247, v169
    v_cvt_pk_bf16_f32 v168, v168, v169
    v_mfma_f32_16x16x32_bf16 v[180:183], a[212:215], v[248:251], v[180:183]
    v_mul_f32 v170, v247, v170
    v_mul_f32 v171, v247, v171
    v_mfma_f32_16x16x32_bf16 v[184:187], a[184:187], v[200:203], v[184:187]
    v_cvt_pk_bf16_f32 v169, v170, v171
    v_mul_f32 v164, v247, v164
    v_mfma_f32_16x16x32_bf16 v[184:187], a[216:219], v[248:251], v[184:187]
    buffer_store_dwordx4 v[236:239], v244, s[20:23], s40 offen offset:2048 nt
    v_mfma_f32_16x16x32_bf16 v[188:191], a[188:191], v[200:203], v[188:191]
    ds_write2_b64 v225, v[160:161], v[168:169] offset0:0 offset1:32
    v_mfma_f32_16x16x32_bf16 v[188:191], a[220:223], v[248:251], v[188:191]
    v_mul_f32 v165, v247, v165
    v_cvt_pk_bf16_f32 v164, v164, v165
    v_mul_f32 v166, v247, v166
    v_mul_f32 v167, v247, v167
    v_cvt_pk_bf16_f32 v165, v166, v167
    v_mul_f32 v172, v247, v172
    buffer_store_dwordx4 v[240:243], v245, s[20:23], s40 offen offset:3072 nt
    s_add_u32 s40, s40, 0x1000
    v_mul_f32 v173, v247, v173
    v_cvt_pk_bf16_f32 v172, v172, v173
    v_mul_f32 v174, v247, v174
    v_mul_f32 v175, v247, v175
    v_cvt_pk_bf16_f32 v173, v174, v175
    v_mul_f32 v176, v247, v176
    v_mul_f32 v177, v247, v177
    ds_write2_b64 v226, v[164:165], v[172:173] offset0:0 offset1:32
    v_cvt_pk_bf16_f32 v176, v176, v177
    v_mul_f32 v178, v247, v178
    v_mul_f32 v179, v247, v179
    v_cvt_pk_bf16_f32 v177, v178, v179
    v_mul_f32 v184, v247, v184
    v_mul_f32 v185, v247, v185
    v_cvt_pk_bf16_f32 v184, v184, v185
    v_mul_f32 v186, v247, v186
    v_mul_f32 v187, v247, v187
    v_cvt_pk_bf16_f32 v185, v186, v187
    ds_write2_b64 v225, v[176:177], v[184:185] offset0:64 offset1:96
    v_mul_f32 v180, v247, v180
    v_mul_f32 v181, v247, v181
    v_cvt_pk_bf16_f32 v180, v180, v181
    v_mul_f32 v182, v247, v182
    v_mul_f32 v183, v247, v183
    v_cvt_pk_bf16_f32 v181, v182, v183
    v_mul_f32 v188, v247, v188
    v_mul_f32 v189, v247, v189
    v_cvt_pk_bf16_f32 v188, v188, v189
    v_mul_f32 v190, v247, v190
    v_mul_f32 v191, v247, v191
    v_cvt_pk_bf16_f32 v189, v190, v191
    ds_write2_b64 v226, v[180:181], v[188:189] offset0:64 offset1:96
    ds_read_b128 v[228:231], v227 offset:0
    ds_read_b128 v[232:235], v227 offset:1024
    ds_read_b128 v[236:239], v227 offset:2048
    ds_read_b128 v[240:243], v227 offset:3072
    s_waitcnt lgkmcnt(0)
    buffer_store_dwordx4 v[228:231], v244, s[20:23], s40 offen sc1
    buffer_store_dwordx4 v[232:235], v245, s[20:23], s40 offen offset:1024 sc1
    buffer_store_dwordx4 v[236:239], v244, s[20:23], s40 offen offset:2048 sc1
    buffer_store_dwordx4 v[240:243], v245, s[20:23], s40 offen offset:3072 sc1
    s_add_u32 s40, s40, 0x1000
    s_or_b64 s[78:79], s[50:51], s[52:53]
    s_cbranch_scc0 L_end
    s_waitcnt vmcnt(0) lgkmcnt(0)
    v_mbcnt_lo_u32_b32 v1, -1, 0
    v_mbcnt_hi_u32_b32 v1, -1, v1
    v_lshrrev_b32 v10, 4, v1
    v_and_b32 v11, 3, v1
    v_bfe_u32 v12, v1, 2, 2
    v_and_b32 v13, 15, v1
    s_mul_i32 s77, s3, 0x6000
    v_lshlrev_b32 v14, 4, v10
    v_lshl_add_u32 v15, v13, 8, v14
    s_mul_i32 s81, s3, 0x6000
    v_add_u32 v2, s81, v15
    v_lshl_add_u32 v15, v12, 3, v11
    v_lshl_add_u32 v3, v15, 8, v14
    v_lshlrev_b32 v15, 8, v12
    v_lshl_add_u32 v15, v10, 6, v15
    v_lshl_add_u32 v4, v11, 4, v15
    v_xor_b32 v5, 32, v4
    s_add_u32 s76, s77, 0x12000
    v_lshlrev_b32 v15, 11, v10
    v_lshl_add_u32 v15, v12, 6, v15
    v_and_b32 v16, 1, v10
    v_lshl_add_u32 v15, v16, 5, v15
    v_lshrrev_b32 v16, 1, v11
    v_lshl_add_u32 v15, v16, 4, v15
    v_and_b32 v16, 1, v11
    v_lshl_add_u32 v15, v16, 3, v15
    v_xor_b32 v16, 32, v15
    v_add_u32 v6, s76, v15
    v_add_u32 v7, s76, v16
    s_add_u32 s81, s77, 0x10000
    v_lshlrev_b32 v15, 10, v12
    v_lshl_add_u32 v15, v11, 6, v15
    v_bfe_u32 v16, v1, 1, 2
    v_lshlrev_b32 v16, 4, v16
    v_lshlrev_b32 v17, 3, v10
    v_xor_b32 v16, v16, v17
    v_add3_u32 v20, v15, v16, s81
    v_xor_b32 v21, 32, v20
    v_lshl_add_u32 v22, v1, 4, s81
    s_mov_b32 s70, 0
L_sl_head:
    s_cmp_eq_u32 s70, 0
    s_cselect_b64 s[78:79], s[50:51], s[52:53]
    s_cmp_eq_u64 s[78:79], 0
    s_cbranch_scc1 L_sl_next
    s_mul_i32 s73, s70, 0x18000
    s_lshl_b32 s75, s70, 17
    s_mov_b32 s71, 0
L_sl_tile:
    buffer_load_dwordx4 a[0:3], v2, s[16:19], s73 offen offset:0
    buffer_load_dwordx4 a[4:7], v2, s[16:19], s73 offen offset:64
    buffer_load_dwordx4 a[8:11], v2, s[16:19], s73 offen offset:128
    buffer_load_dwordx4 a[12:15], v2, s[16:19], s73 offen offset:192
    v_mov_b32 v8, 0xff800000
    s_mov_b32 s74, s75
    s_mov_b32 s72, 16
L_sl_p1:
    buffer_load_dwordx4 a[96:99], v3, s[8:11], s74 offen offset:0
    buffer_load_dwordx4 a[100:103], v3, s[8:11], s74 offen offset:64
    buffer_load_dwordx4 a[104:107], v3, s[8:11], s74 offen offset:128
    buffer_load_dwordx4 a[108:111], v3, s[8:11], s74 offen offset:192
    buffer_load_dwordx4 a[112:115], v3, s[8:11], s74 offen offset:1024
    buffer_load_dwordx4 a[116:119], v3, s[8:11], s74 offen offset:1088
    buffer_load_dwordx4 a[120:123], v3, s[8:11], s74 offen offset:1152
    buffer_load_dwordx4 a[124:127], v3, s[8:11], s74 offen offset:1216
    s_waitcnt vmcnt(0)
    v_mfma_f32_16x16x32_bf16 v[96:99], a[96:99], a[0:3], 0
    v_mfma_f32_16x16x32_bf16 v[96:99], a[100:103], a[4:7], v[96:99]
    v_mfma_f32_16x16x32_bf16 v[96:99], a[104:107], a[8:11], v[96:99]
    v_mfma_f32_16x16x32_bf16 v[96:99], a[108:111], a[12:15], v[96:99]
    v_mfma_f32_16x16x32_bf16 v[100:103], a[112:115], a[0:3], 0
    s_nop 0
    v_mfma_f32_16x16x32_bf16 v[100:103], a[116:119], a[4:7], v[100:103]
    s_nop 0
    v_mfma_f32_16x16x32_bf16 v[100:103], a[120:123], a[8:11], v[100:103]
    s_nop 0
    v_mfma_f32_16x16x32_bf16 v[100:103], a[124:127], a[12:15], v[100:103]
    s_nop 0
    v_max3_f32 v8, v8, v96, v97
    v_max3_f32 v8, v8, v98, v99
    s_nop 4
    v_max3_f32 v8, v8, v100, v101
    v_max3_f32 v8, v8, v102, v103
    s_add_u32 s74, s74, 0x2000
    s_sub_u32 s72, s72, 1
    s_cmp_lg_u32 s72, 0
    s_cbranch_scc1 L_sl_p1
    v_mov_b32 v9, v8
    s_nop 1
    v_permlane16_swap_b32 v9, v8
    v_max_f32 v8, v8, v9
    v_mov_b32 v9, v8
    s_nop 1
    v_permlane32_swap_b32 v9, v8
    v_max_f32 v8, v8, v9
    v_mul_f32 v8, s33, v8
    v_mov_b32 v64, 0
    v_mov_b32 v65, 0
    v_mov_b32 v66, 0
    v_mov_b32 v67, 0
    v_mov_b32 v68, 0
    v_mov_b32 v69, 0
    v_mov_b32 v70, 0
    v_mov_b32 v71, 0
    v_mov_b32 v72, 0
    v_mov_b32 v73, 0
    v_mov_b32 v74, 0
    v_mov_b32 v75, 0
    v_mov_b32 v76, 0
    v_mov_b32 v77, 0
    v_mov_b32 v78, 0
    v_mov_b32 v79, 0
    v_mov_b32 v80, 0
    v_mov_b32 v81, 0
    v_mov_b32 v82, 0
    v_mov_b32 v83, 0
    v_mov_b32 v84, 0
    v_mov_b32 v85, 0
    v_mov_b32 v86, 0
    v_mov_b32 v87, 0
    v_mov_b32 v88, 0
    v_mov_b32 v89, 0
    v_mov_b32 v90, 0
    v_mov_b32 v91, 0
    v_mov_b32 v92, 0
    v_mov_b32 v93, 0
    v_mov_b32 v94, 0
    v_mov_b32 v95, 0
    v_accvgpr_write_b32 a224, 0
    v_accvgpr_write_b32 a225, 0
    v_accvgpr_write_b32 a226, 0
    v_accvgpr_write_b32 a227, 0
    s_mov_b32 s74, s75
    s_mov_b32 s72, 16
L_sl_p2:
    buffer_load_dwordx4 a[96:99], v3, s[8:11], s74 offen offset:0
    buffer_load_dwordx4 a[100:103], v3, s[8:11], s74 offen offset:64
    buffer_load_dwordx4 a[104:107], v3, s[8:11], s74 offen offset:128
    buffer_load_dwordx4 a[108:111], v3, s[8:11], s74 offen offset:192
    buffer_load_dwordx4 a[112:115], v3, s[8:11], s74 offen offset:1024
    buffer_load_dwordx4 a[116:119], v3, s[8:11], s74 offen offset:1088
    buffer_load_dwordx4 a[120:123], v3, s[8:11], s74 offen offset:1152
    buffer_load_dwordx4 a[124:127], v3, s[8:11], s74 offen offset:1216
    s_add_u32 m0, s76, 0x0
    s_add_u32 s80, s74, 0x0
    buffer_load_dwordx4 v4, s[12:15], s80 offen offset:0 lds
    buffer_load_dwordx4 v4, s[12:15], s80 offen offset:1024 lds
    buffer_load_dwordx4 v5, s[12:15], s80 offen offset:2048 lds
    buffer_load_dwordx4 v5, s[12:15], s80 offen offset:3072 lds
    s_add_u32 m0, s76, 0x1000
    s_add_u32 s80, s74, 0x1000
    buffer_load_dwordx4 v4, s[12:15], s80 offen offset:0 lds
    buffer_load_dwordx4 v4, s[12:15], s80 offen offset:1024 lds
    buffer_load_dwordx4 v5, s[12:15], s80 offen offset:2048 lds
    buffer_load_dwordx4 v5, s[12:15], s80 offen offset:3072 lds
    s_waitcnt vmcnt(0)
    v_mfma_f32_16x16x32_bf16 v[96:99], a[96:99], a[0:3], 0
    v_mfma_f32_16x16x32_bf16 v[96:99], a[100:103], a[4:7], v[96:99]
    v_mfma_f32_16x16x32_bf16 v[96:99], a[104:107], a[8:11], v[96:99]
    v_mfma_f32_16x16x32_bf16 v[96:99], a[108:111], a[12:15], v[96:99]
    v_mfma_f32_16x16x32_bf16 v[100:103], a[112:115], a[0:3], 0
    v_mfma_f32_16x16x32_bf16 v[100:103], a[116:119], a[4:7], v[100:103]
    v_mfma_f32_16x16x32_bf16 v[100:103], a[120:123], a[8:11], v[100:103]
    v_mfma_f32_16x16x32_bf16 v[100:103], a[124:127], a[12:15], v[100:103]
    ds_read_b64_tr_b16 a[160:161], v6 offset:0
    ds_read_b64_tr_b16 a[162:163], v6 offset:1024
    ds_read_b64_tr_b16 a[164:165], v7 offset:0
    ds_read_b64_tr_b16 a[166:167], v7 offset:1024
    ds_read_b64_tr_b16 a[168:169], v6 offset:256
    ds_read_b64_tr_b16 a[170:171], v6 offset:1280
    ds_read_b64_tr_b16 a[172:173], v7 offset:256
    ds_read_b64_tr_b16 a[174:175], v7 offset:1280
    ds_read_b64_tr_b16 a[176:177], v6 offset:512
    ds_read_b64_tr_b16 a[178:179], v6 offset:1536
    ds_read_b64_tr_b16 a[180:181], v7 offset:512
    ds_read_b64_tr_b16 a[182:183], v7 offset:1536
    ds_read_b64_tr_b16 a[184:185], v6 offset:768
    ds_read_b64_tr_b16 a[186:187], v6 offset:1792
    ds_read_b64_tr_b16 a[188:189], v7 offset:768
    ds_read_b64_tr_b16 a[190:191], v7 offset:1792
    v_fma_f32 v96, v96, s32, v8
    v_fma_f32 v97, v97, s32, v8
    v_fma_f32 v98, v98, s32, v8
    v_fma_f32 v99, v99, s32, v8
    v_fma_f32 v100, v100, s32, v8
    v_fma_f32 v101, v101, s32, v8
    v_fma_f32 v102, v102, s32, v8
    v_fma_f32 v103, v103, s32, v8
    v_exp_f32 v96, v96
    v_exp_f32 v97, v97
    v_exp_f32 v98, v98
    v_exp_f32 v99, v99
    v_exp_f32 v100, v100
    v_exp_f32 v101, v101
    v_exp_f32 v102, v102
    v_exp_f32 v103, v103
    v_cvt_pk_bf16_f32 v96, v96, v97
    v_cvt_pk_bf16_f32 v97, v98, v99
    v_cvt_pk_bf16_f32 v98, v100, v101
    v_cvt_pk_bf16_f32 v99, v102, v103
    s_waitcnt lgkmcnt(0)
    s_nop 0
    v_mfma_f32_16x16x32_bf16 v[64:67], a[160:163], v[96:99], v[64:67]
    v_mfma_f32_16x16x32_bf16 v[68:71], a[164:167], v[96:99], v[68:71]
    v_mfma_f32_16x16x32_bf16 v[72:75], a[168:171], v[96:99], v[72:75]
    v_mfma_f32_16x16x32_bf16 v[76:79], a[172:175], v[96:99], v[76:79]
    v_mfma_f32_16x16x32_bf16 v[80:83], a[176:179], v[96:99], v[80:83]
    v_mfma_f32_16x16x32_bf16 v[84:87], a[180:183], v[96:99], v[84:87]
    v_mfma_f32_16x16x32_bf16 v[88:91], a[184:187], v[96:99], v[88:91]
    v_mfma_f32_16x16x32_bf16 v[92:95], a[188:191], v[96:99], v[92:95]
    v_mfma_f32_16x16x32_bf16 a[224:227], a[248:251], v[96:99], a[224:227]
    s_add_u32 s74, s74, 0x2000
    s_sub_u32 s72, s72, 1
    s_cmp_lg_u32 s72, 0
    s_cbranch_scc1 L_sl_p2
    s_nop 3
    v_accvgpr_read_b32 v9, a224
    v_rcp_f32 v9, v9
    s_nop 0
    v_mul_f32 v64, v9, v64
    v_mul_f32 v65, v9, v65
    v_mul_f32 v66, v9, v66
    v_mul_f32 v67, v9, v67
    v_mul_f32 v68, v9, v68
    v_mul_f32 v69, v9, v69
    v_mul_f32 v70, v9, v70
    v_mul_f32 v71, v9, v71
    v_mul_f32 v72, v9, v72
    v_mul_f32 v73, v9, v73
    v_mul_f32 v74, v9, v74
    v_mul_f32 v75, v9, v75
    v_mul_f32 v76, v9, v76
    v_mul_f32 v77, v9, v77
    v_mul_f32 v78, v9, v78
    v_mul_f32 v79, v9, v79
    v_mul_f32 v80, v9, v80
    v_mul_f32 v81, v9, v81
    v_mul_f32 v82, v9, v82
    v_mul_f32 v83, v9, v83
    v_mul_f32 v84, v9, v84
    v_mul_f32 v85, v9, v85
    v_mul_f32 v86, v9, v86
    v_mul_f32 v87, v9, v87
    v_mul_f32 v88, v9, v88
    v_mul_f32 v89, v9, v89
    v_mul_f32 v90, v9, v90
    v_mul_f32 v91, v9, v91
    v_mul_f32 v92, v9, v92
    v_mul_f32 v93, v9, v93
    v_mul_f32 v94, v9, v94
    v_mul_f32 v95, v9, v95
    v_cvt_pk_bf16_f32 v64, v64, v65
    v_cvt_pk_bf16_f32 v65, v66, v67
    v_cvt_pk_bf16_f32 v68, v68, v69
    v_cvt_pk_bf16_f32 v69, v70, v71
    v_cvt_pk_bf16_f32 v72, v72, v73
    v_cvt_pk_bf16_f32 v73, v74, v75
    v_cvt_pk_bf16_f32 v76, v76, v77
    v_cvt_pk_bf16_f32 v77, v78, v79
    v_cvt_pk_bf16_f32 v80, v80, v81
    v_cvt_pk_bf16_f32 v81, v82, v83
    v_cvt_pk_bf16_f32 v84, v84, v85
    v_cvt_pk_bf16_f32 v85, v86, v87
    v_cvt_pk_bf16_f32 v88, v88, v89
    v_cvt_pk_bf16_f32 v89, v90, v91
    v_cvt_pk_bf16_f32 v92, v92, v93
    v_cvt_pk_bf16_f32 v93, v94, v95
    ds_write2_b64 v20, v[64:65], v[72:73] offset0:0 offset1:32
    ds_write2_b64 v21, v[68:69], v[76:77] offset0:0 offset1:32
    ds_write2_b64 v20, v[80:81], v[88:89] offset0:64 offset1:96
    ds_write2_b64 v21, v[84:85], v[92:93] offset0:64 offset1:96
    ds_read_b128 v[228:231], v22 offset:0
    ds_read_b128 v[232:235], v22 offset:1024
    ds_read_b128 v[236:239], v22 offset:2048
    ds_read_b128 v[240:243], v22 offset:3072
    s_waitcnt lgkmcnt(0)
    buffer_store_dwordx4 v[228:231], v244, s[20:23], s73 offen nt
    buffer_store_dwordx4 v[232:235], v245, s[20:23], s73 offen offset:1024 nt
    buffer_store_dwordx4 v[236:239], v244, s[20:23], s73 offen offset:2048 nt
    buffer_store_dwordx4 v[240:243], v245, s[20:23], s73 offen offset:3072 nt
    s_waitcnt vmcnt(0)
    s_add_u32 s73, s73, 0x1000
    s_add_u32 s71, s71, 1
    s_cmp_lg_u32 s71, 6
    s_cbranch_scc1 L_sl_tile
L_sl_next:
    s_add_u32 s70, s70, 1
    s_cmp_lg_u32 s70, 2
    s_cbranch_scc1 L_sl_head
L_end:
    s_endpgm
L_codeend:
.section .rodata,"a"
.p2align 6
.amdhsa_kernel standalone__gqa_softmax__near_ridge_kernel
  .amdhsa_next_free_vgpr 512
  .amdhsa_next_free_sgpr 96
  .amdhsa_accum_offset 256
  .amdhsa_group_segment_fixed_size 0
  .amdhsa_kernarg_size 48
  .amdhsa_user_sgpr_count 2
  .amdhsa_user_sgpr_kernarg_segment_ptr 1
  .amdhsa_system_sgpr_workgroup_id_x 1
  .amdhsa_float_denorm_mode_32 3
.end_amdhsa_kernel
```
